```python
import torch

def _softmax(x, axis=-1):
    return torch.softmax(x, dim=axis)
def _gelu(x):
    return torch.nn.functional.gelu(x, approximate="tanh")
def _silu(x):
    return torch.nn.functional.silu(x)
def _sigmoid(x):
    return torch.sigmoid(x)
def _layernorm(x, axis=-1, eps=1e-5):
    m = x.mean(dim=axis, keepdim=True)
    v = x.var(dim=axis, keepdim=True, unbiased=False)
    return (x - m) / torch.sqrt(v + eps)
def _scatter_add(tgt, idx, src, axis=0):
    return tgt.clone().index_add_(axis, idx, src)
def _segment_sum(src, seg, n):
    out = torch.zeros((n,) + src.shape[1:], dtype=src.dtype)
    return out.index_add_(0, seg, src)
def _pad(x, pw):
    flat = tuple(v for pair in reversed(pw) for v in pair)
    return torch.nn.functional.pad(x, flat)

kernel_name = 'standalone__dense_activation_gelu__prompt'

def setup_inputs():

    _w = (lambda a: (lambda t: t.to(torch.bfloat16) if t.is_floating_point() else t)(torch.as_tensor(a)))
    B, S, D, F = 1, 2048, 448, 1792
    return {
        "x": _w((lambda *s: torch.randn(*s, dtype=torch.bfloat16) * 0.05)(B, S, D)),
        "w1": _w((lambda *s: torch.randn(*s, dtype=torch.bfloat16) * 3.2)(D, F) * (D ** -0.5)),
        "b1": _w((lambda *s: torch.randn(*s, dtype=torch.bfloat16) * 3.2)(F) * 0.01),
        "w2": _w((lambda *s: torch.randn(*s, dtype=torch.bfloat16) * 0.05)(F, D) * (F ** -0.5)),
        "b2": _w((lambda *s: torch.randn(*s, dtype=torch.bfloat16) * 0.1)(D) * 0.01),
    }

def reference(x, w1, b1, w2, b2):
    h = torch.einsum("bsd,df->bsf", x, w1) + b1
    h = _gelu(h)
    return torch.einsum("bsf,fd->bsd", h, w2) + b2
```

```asm
; @launch grid=(256,1,1) block=(768,1,1) lds=163840
.amdgcn_target "amdgcn-amd-amdhsa--gfx950"
.text
.globl standalone__dense_activation_gelu__prompt_kernel
.p2align 8
.type standalone__dense_activation_gelu__prompt_kernel,@function
standalone__dense_activation_gelu__prompt_kernel:
    s_cmp_ge_u32 s2, 224
    s_cbranch_scc1 L_hstub
    s_load_dwordx2 s[4:5], s[0:1], 0
    s_load_dwordx2 s[8:9], s[0:1], 8
    s_load_dwordx2 s[12:13], s[0:1], 24
    s_load_dwordx2 s[16:17], s[0:1], 56
    s_load_dwordx2 s[20:21], s[0:1], 40
    s_load_dwordx2 s[24:25], s[0:1], 16
    s_load_dwordx2 s[28:29], s[0:1], 32
    s_load_dwordx2 s[32:33], s[0:1], 48
    v_lshrrev_b32 v1, 6, v0
    v_and_b32 v0, 63, v0
    s_and_b32 s40, s2, 7
    v_readfirstlane_b32 s3, v1
    s_lshr_b32 s41, s2, 3
    s_and_b32 s36, s40, 1
    s_lshr_b32 s37, s40, 1
    s_mul_i32 s44, s41, 37
    s_lshr_b32 s44, s44, 8
    s_mul_i32 s51, s44, 7
    s_sub_u32 s45, s41, s51
    s_lshl_b32 s42, s37, 2
    s_add_u32 s42, s42, s44
    s_mul_i32 s43, s36, 7
    s_add_u32 s43, s43, s45
    s_and_b32 s94, s3, 3
    s_mov_b32 s18, 0x10000000
    s_mov_b32 s19, 0x20000
    s_mov_b32 s59, 0
    s_sub_u32 s3, s3, 4
    s_cbranch_scc0 L_compute
    s_add_u32 s3, s3, 12
    s_lshl_b32 s50, s44, 1
    s_add_u32 s50, s50, s37
    s_add_u32 s50, s50, s45
    s_mul_i32 s51, s36, 3
    s_add_u32 s50, s50, s51
    s_mul_i32 s51, s50, 37
    s_lshr_b32 s51, s51, 8
    s_mul_i32 s51, s51, 7
    s_sub_u32 s53, s50, s51
    v_lshrrev_b32 v2, 4, v0
    v_and_b32 v4, 15, v0
    s_lshl_b32 s50, s94, 4
    v_add_u32 v5, s50, v2
    v_mul_u32_u24 v5, 3584, v5
    v_lshlrev_b32 v6, 2, v2
    v_xor_b32 v6, v6, v4
    v_lshl_add_u32 v24, v6, 4, v5
    s_lshl_b32 s50, s43, 8
    v_add_u32 v24, s50, v24
    s_mov_b32 s10, 1605632
    s_mov_b32 s11, 0x20000
    s_lshl_b32 s58, s94, 12
    s_add_u32 s58, s58, 49152
    s_mul_i32 s51, s53, 229376
    s_mov_b32 m0, s58
    s_waitcnt lgkmcnt(0)
    buffer_load_dwordx4 v24, s[8:11], s51 offen lds
    v_add_u32 v25, 13312, v24
    buffer_load_dwordx4 v25, s[8:11], s51 offen offset:1024 lds
    v_add_u32 v26, 26624, v24
    buffer_load_dwordx4 v26, s[8:11], s51 offen offset:2048 lds
    v_add_u32 v27, 39936, v24
    buffer_load_dwordx4 v27, s[8:11], s51 offen offset:3072 lds
    v_lshrrev_b32 v1, 3, v0
    v_and_b32 v3, 7, v0
    s_xor_b32 s51, s36, 1
    s_lshl_b32 s51, s51, 6
    s_lshl_b32 s50, s42, 7
    s_add_u32 s50, s50, s51
    s_lshl_b32 s51, s94, 4
    s_add_u32 s50, s50, s51
    v_add_u32 v5, s50, v1
    v_mul_u32_u24 v5, 896, v5
    v_xor_b32 v6, v3, v2
    v_lshl_add_u32 v20, v6, 4, v5
    v_xor_b32 v6, 4, v6
    v_lshl_add_u32 v21, v6, 4, v5
    v_add_u32 v21, 6144, v21
    s_mov_b32 s6, 1835008
    s_mov_b32 s7, 0x20000
    s_lshl_b32 s57, s94, 11
    s_lshl_b32 s50, s53, 7
    s_mov_b32 m0, s57
    s_mov_b32 s14, 1605632
    buffer_load_dwordx4 v20, s[4:7], s50 offen lds
    buffer_load_dwordx4 v21, s[4:7], s50 offen offset:1024 lds
    s_mov_b32 s15, 0x20000
    s_mov_b32 s54, 1
    s_add_u32 s55, s57, 8192
    s_add_u32 s56, s58, 16384
    s_add_u32 s53, s53, 2
    s_cmp_ge_u32 s53, 7
    s_cselect_b32 s52, 7, 0
    s_sub_u32 s53, s53, s52
L_ld_loop:
    s_lshl_b32 s50, s53, 7
    s_mul_i32 s51, s53, 229376
    s_mov_b32 m0, s55
    s_add_u32 s53, s53, 2
    s_cmp_ge_u32 s53, 7
    s_cselect_b32 s52, 7, 0
    s_sub_u32 s53, s53, s52
    s_waitcnt vmcnt(6)
    buffer_load_dwordx4 v20, s[4:7], s50 offen lds
    s_waitcnt vmcnt(6)
    buffer_load_dwordx4 v21, s[4:7], s50 offen offset:1024 lds
    s_mov_b32 m0, s56
    s_add_u32 s56, s56, 16384
    s_add_u32 s55, s55, 8192
    s_add_u32 s54, s54, 1
    s_waitcnt vmcnt(6)
    buffer_load_dwordx4 v24, s[8:11], s51 offen offset:0 lds
    s_waitcnt vmcnt(6)
    buffer_load_dwordx4 v25, s[8:11], s51 offen offset:1024 lds
    s_waitcnt vmcnt(6)
    buffer_load_dwordx4 v26, s[8:11], s51 offen offset:2048 lds
    s_waitcnt vmcnt(6)
    buffer_load_dwordx4 v27, s[8:11], s51 offen offset:3072 lds
    s_cmp_eq_u32 s54, 5
    s_cselect_b32 s55, s57, s55
    s_cmp_eq_u32 s54, 1
    s_cbranch_scc1 L_ld_loop
    s_waitcnt vmcnt(6)
    s_barrier
    s_cmp_lt_u32 s54, 7
    s_cbranch_scc1 L_ld_loop
    s_branch L_ld_tail
L_hstub:
    s_getpc_b64 s[56:57]
    v_lshlrev_b32 v5, 7, v0
    v_min_u32 v5, L_code_end-L_hstub-256, v5
    v_cmp_gt_u32 vcc, 128, v0
    s_cbranch_vccz L_helper
    global_load_dword v31, v5, s[56:57]
    s_branch L_helper
L_compute:
    s_and_b32 s48, s3, 1
    s_bfe_u32 s49, s3, 0x10001
    s_lshl_b32 s50, s43, 8
    s_lshl_b32 s51, s49, 7
    s_add_u32 s54, s50, s51
    s_add_u32 s55, s54, 64
    s_add_u32 s53, s54, 96
    s_lshr_b32 s60, s3, 2
    v_lshlrev_b32 v14, 2, v0
    v_mov_b32 v5, 0
    ds_write_b32 v14, v5 offset:40960
    v_lshrrev_b32 v2, 5, v0
    v_and_b32 v1, 31, v0
    v_and_b32 v3, 15, v0
    v_bfe_u32 v29, v0, 4, 1
    v_lshlrev_b32 v14, 4, v0
    v_lshrrev_b32 v28, 2, v3
    v_and_b32 v15, 3, v3
    v_lshlrev_b32 v15, 3, v15
    v_lshl_add_u32 v29, v29, 5, v15
    s_waitcnt lgkmcnt(0)
    s_load_dwordx16 s[68:83], s[24:25], s54
    s_load_dwordx8 s[84:91], s[24:25], s55
    s_load_dwordx8 s[4:11], s[24:25], s53
    s_lshl_b32 s50, s48, 12
    v_lshlrev_b32 v6, 7, v1
    v_add_u32 v6, s50, v6
    v_bfe_u32 v10, v1, 1, 3
    v_xor_b32 v10, v10, v2
    v_lshl_add_u32 v6, v10, 4, v6
    v_xor_b32 v7, 32, v6
    v_xor_b32 v8, 64, v6
    v_xor_b32 v9, 96, v6
    v_lshl_add_u32 v11, v2, 3, v28
    v_lshl_add_u32 v11, v11, 8, v29
    v_add_u32 v11, 49152, v11
    s_lshl_b32 s50, s49, 1
    v_xor_b32 v10, s50, v28
    v_lshl_add_u32 v10, v10, 6, v11
    v_xor_b32 v11, 64, v10
    v_lshl_add_u32 v18, v2, 2, v28
    v_lshl_add_u32 v18, v18, 7, v29
    v_lshrrev_b32 v16, 3, v3
    v_lshl_add_u32 v12, v16, 6, v18
    s_lshl_b32 s50, s49, 13
    s_add_u32 s50, s50, 49152
    v_add_u32 v12, s50, v12
    v_add_u32 v3, 65536, v10
    v_add_u32 v4, 65536, v11
    s_mov_b32 s34, 256
    s_mov_b32 s35, 0x20000
    s_lshl_b32 s52, s40, 3
    v_mov_b32 v17, s52
    v_and_b32 v19, 3, v0
    v_lshlrev_b32 v19, 2, v19
    v_add_u32 v19, 40960, v19
    s_lshl_b32 s51, s3, 2
    s_add_u32 s51, s51, 40960
    v_mov_b32 v164, s51
    s_xor_b32 s61, s60, s36
    s_xor_b32 s61, s61, 1
    s_lshl_b32 s50, s42, 2
    s_lshl_b32 s51, s61, 1
    s_add_u32 s50, s50, s51
    s_add_u32 s50, s50, s48
    s_mul_i32 s50, s50, 112
    s_mul_i32 s51, s36, 56
    s_add_u32 s50, s50, s51
    s_lshl_b32 s51, s49, 2
    s_add_u32 s50, s50, s51
    s_lshl_b32 s50, s50, 10
    v_add_u32 v18, s50, v14
    s_lshl_b32 s46, s45, 13
    s_mov_b32 s56, 0xbdd2d3e8
    s_mov_b32 s57, 0xc0135761
    s_lshl_b32 s50, s41, 3
    s_or_b32 s50, s50, s3
    s_cmp_lg_u32 s50, 7
    s_cbranch_scc1 L_notag
    s_memrealtime s[52:53]
    s_waitcnt lgkmcnt(0)
    s_or_b32 s52, s52, 1
    v_mov_b32 v30, s52
    v_mov_b32 v31, s53
    s_mov_b64 exec, 1
    buffer_store_dwordx2 v[30:31], v17, s[32:35], 0 offen sc1
    s_mov_b64 exec, -1
L_notag:
    s_waitcnt lgkmcnt(0)
    v_mov_b32 v32, s68
    v_mov_b32 v33, s69
    v_mov_b32 v34, s72
    v_mov_b32 v35, s73
    v_mov_b32 v36, s76
    v_mov_b32 v37, s77
    v_mov_b32 v38, s80
    v_mov_b32 v39, s81
    s_mov_b32 exec_lo, 0
    v_mov_b32 v32, s70
    v_mov_b32 v33, s71
    v_mov_b32 v34, s74
    v_mov_b32 v35, s75
    v_mov_b32 v36, s78
    v_mov_b32 v37, s79
    v_mov_b32 v38, s82
    v_mov_b32 v39, s83
    s_mov_b32 exec_lo, -1
    v_mov_b32 v40, s84
    v_mov_b32 v41, s85
    v_mov_b32 v42, s88
    v_mov_b32 v43, s89
    v_mov_b32 v44, s4
    v_mov_b32 v45, s5
    v_mov_b32 v46, s8
    v_mov_b32 v47, s9
    s_mov_b32 exec_lo, 0
    v_mov_b32 v40, s86
    v_mov_b32 v41, s87
    v_mov_b32 v42, s90
    v_mov_b32 v43, s91
    v_mov_b32 v44, s6
    v_mov_b32 v45, s7
    v_mov_b32 v46, s10
    v_mov_b32 v47, s11
    s_mov_b32 exec_lo, -1
    v_lshlrev_b32 v80, 16, v32
    v_and_b32 v81, 0xffff0000, v32
    v_lshlrev_b32 v82, 16, v33
    v_and_b32 v83, 0xffff0000, v33
    v_lshlrev_b32 v84, 16, v34
    v_and_b32 v85, 0xffff0000, v34
    v_lshlrev_b32 v86, 16, v35
    v_and_b32 v87, 0xffff0000, v35
    v_lshlrev_b32 v88, 16, v36
    v_and_b32 v89, 0xffff0000, v36
    v_lshlrev_b32 v90, 16, v37
    v_and_b32 v91, 0xffff0000, v37
    v_lshlrev_b32 v92, 16, v38
    v_and_b32 v93, 0xffff0000, v38
    v_lshlrev_b32 v94, 16, v39
    v_and_b32 v95, 0xffff0000, v39
    v_lshlrev_b32 v96, 16, v40
    v_and_b32 v97, 0xffff0000, v40
    v_lshlrev_b32 v98, 16, v41
    v_and_b32 v99, 0xffff0000, v41
    v_lshlrev_b32 v100, 16, v42
    v_and_b32 v101, 0xffff0000, v42
    v_lshlrev_b32 v102, 16, v43
    v_and_b32 v103, 0xffff0000, v43
    v_lshlrev_b32 v104, 16, v44
    v_and_b32 v105, 0xffff0000, v44
    v_lshlrev_b32 v106, 16, v45
    v_and_b32 v107, 0xffff0000, v45
    v_lshlrev_b32 v108, 16, v46
    v_and_b32 v109, 0xffff0000, v46
    v_lshlrev_b32 v110, 16, v47
    v_and_b32 v111, 0xffff0000, v47
    v_mov_b32 v20, 0
    v_mov_b32 v21, 0
    v_mov_b32 v22, 0
    v_mov_b32 v23, 0
    v_mov_b32 v24, 0
    v_mov_b32 v25, 0
    v_mov_b32 v26, 0
    v_mov_b32 v27, 0
    s_cmp_eq_u32 s60, 0
    s_cbranch_scc0 L_passk
    s_barrier
    s_waitcnt lgkmcnt(0)
    ds_read_b128 v[32:35], v6 offset:0
    ds_read_b64_tr_b16 v[36:37], v10 offset:0
    ds_read_b64_tr_b16 v[38:39], v10 offset:1024
    ds_read_b64_tr_b16 v[40:41], v11 offset:0
    ds_read_b64_tr_b16 v[42:43], v11 offset:1024
    ds_read_b128 v[44:47], v7 offset:0
    ds_read_b64_tr_b16 v[48:49], v10 offset:4096
    ds_read_b64_tr_b16 v[50:51], v10 offset:5120
    ds_read_b64_tr_b16 v[52:53], v11 offset:4096
    ds_read_b64_tr_b16 v[54:55], v11 offset:5120
    ds_read_b128 v[56:59], v8 offset:0
    ds_read_b64_tr_b16 v[60:61], v10 offset:8192
    ds_read_b64_tr_b16 v[62:63], v10 offset:9216
    ds_read_b64_tr_b16 v[64:65], v11 offset:8192
    ds_read_b64_tr_b16 v[66:67], v11 offset:9216
    s_waitcnt lgkmcnt(12)
    v_mfma_f32_32x32x16_bf16 v[80:95], v[36:39], v[32:35], v[80:95]
    ds_read_b128 v[68:71], v9 offset:0
    ds_read_b64_tr_b16 v[72:73], v10 offset:12288
    ds_read_b64_tr_b16 v[74:75], v10 offset:13312
    s_waitcnt lgkmcnt(13)
    v_mfma_f32_32x32x16_bf16 v[96:111], v[40:43], v[32:35], v[96:111]
    ds_read_b64_tr_b16 v[76:77], v11 offset:12288
    ds_read_b64_tr_b16 v[78:79], v11 offset:13312
    s_waitcnt lgkmcnt(12)
    v_mfma_f32_32x32x16_bf16 v[80:95], v[48:51], v[44:47], v[80:95]
    s_barrier
    ds_read_b128 v[32:35], v6 offset:8192
    ds_read_b64_tr_b16 v[36:37], v10 offset:16384
    ds_read_b64_tr_b16 v[38:39], v10 offset:17408
    s_waitcnt lgkmcnt(13)
    v_mfma_f32_32x32x16_bf16 v[96:111], v[52:55], v[44:47], v[96:111]
    ds_read_b64_tr_b16 v[40:41], v11 offset:16384
    ds_read_b64_tr_b16 v[42:43], v11 offset:17408
    s_waitcnt lgkmcnt(12)
    v_mfma_f32_32x32x16_bf16 v[80:95], v[60:63], v[56:59], v[80:95]
    ds_read_b128 v[44:47], v7 offset:8192
    ds_read_b64_tr_b16 v[48:49], v10 offset:20480
    ds_read_b64_tr_b16 v[50:51], v10 offset:21504
    s_waitcnt lgkmcnt(13)
    v_mfma_f32_32x32x16_bf16 v[96:111], v[64:67], v[56:59], v[96:111]
    ds_read_b64_tr_b16 v[52:53], v11 offset:20480
    ds_read_b64_tr_b16 v[54:55], v11 offset:21504
    s_waitcnt lgkmcnt(12)
    v_mfma_f32_32x32x16_bf16 v[80:95], v[72:75], v[68:71], v[80:95]
    ds_read_b128 v[56:59], v8 offset:8192
    ds_read_b64_tr_b16 v[60:61], v10 offset:24576
    ds_read_b64_tr_b16 v[62:63], v10 offset:25600
    s_waitcnt lgkmcnt(13)
    v_mfma_f32_32x32x16_bf16 v[96:111], v[76:79], v[68:71], v[96:111]
    ds_read_b64_tr_b16 v[64:65], v11 offset:24576
    ds_read_b64_tr_b16 v[66:67], v11 offset:25600
    s_waitcnt lgkmcnt(12)
    v_mfma_f32_32x32x16_bf16 v[80:95], v[36:39], v[32:35], v[80:95]
    ds_read_b128 v[68:71], v9 offset:8192
    ds_read_b64_tr_b16 v[72:73], v10 offset:28672
    ds_read_b64_tr_b16 v[74:75], v10 offset:29696
    s_waitcnt lgkmcnt(13)
    v_mfma_f32_32x32x16_bf16 v[96:111], v[40:43], v[32:35], v[96:111]
    ds_read_b64_tr_b16 v[76:77], v11 offset:28672
    ds_read_b64_tr_b16 v[78:79], v11 offset:29696
    s_waitcnt lgkmcnt(12)
    v_mfma_f32_32x32x16_bf16 v[80:95], v[48:51], v[44:47], v[80:95]
    s_barrier
    ds_read_b128 v[32:35], v6 offset:16384
    ds_read_b64_tr_b16 v[36:37], v10 offset:32768
    ds_read_b64_tr_b16 v[38:39], v10 offset:33792
    s_waitcnt lgkmcnt(13)
    v_mfma_f32_32x32x16_bf16 v[96:111], v[52:55], v[44:47], v[96:111]
    ds_read_b64_tr_b16 v[40:41], v11 offset:32768
    ds_read_b64_tr_b16 v[42:43], v11 offset:33792
    s_waitcnt lgkmcnt(12)
    v_mfma_f32_32x32x16_bf16 v[80:95], v[60:63], v[56:59], v[80:95]
    ds_read_b128 v[44:47], v7 offset:16384
    ds_read_b64_tr_b16 v[48:49], v10 offset:36864
    ds_read_b64_tr_b16 v[50:51], v10 offset:37888
    s_waitcnt lgkmcnt(13)
    v_mfma_f32_32x32x16_bf16 v[96:111], v[64:67], v[56:59], v[96:111]
    ds_read_b64_tr_b16 v[52:53], v11 offset:36864
    ds_read_b64_tr_b16 v[54:55], v11 offset:37888
    s_waitcnt lgkmcnt(12)
    v_mfma_f32_32x32x16_bf16 v[80:95], v[72:75], v[68:71], v[80:95]
    ds_read_b128 v[56:59], v8 offset:16384
    ds_read_b64_tr_b16 v[60:61], v10 offset:40960
    ds_read_b64_tr_b16 v[62:63], v10 offset:41984
    s_waitcnt lgkmcnt(13)
    v_mfma_f32_32x32x16_bf16 v[96:111], v[76:79], v[68:71], v[96:111]
    ds_read_b64_tr_b16 v[64:65], v11 offset:40960
    ds_read_b64_tr_b16 v[66:67], v11 offset:41984
    s_waitcnt lgkmcnt(12)
    v_mfma_f32_32x32x16_bf16 v[80:95], v[36:39], v[32:35], v[80:95]
    ds_read_b128 v[68:71], v9 offset:16384
    ds_read_b64_tr_b16 v[72:73], v10 offset:45056
    ds_read_b64_tr_b16 v[74:75], v10 offset:46080
    s_waitcnt lgkmcnt(13)
    v_mfma_f32_32x32x16_bf16 v[96:111], v[40:43], v[32:35], v[96:111]
    ds_read_b64_tr_b16 v[76:77], v11 offset:45056
    ds_read_b64_tr_b16 v[78:79], v11 offset:46080
    s_waitcnt lgkmcnt(12)
    v_mfma_f32_32x32x16_bf16 v[80:95], v[48:51], v[44:47], v[80:95]
    s_barrier
    ds_read_b128 v[32:35], v6 offset:24576
    ds_read_b64_tr_b16 v[36:37], v10 offset:49152
    ds_read_b64_tr_b16 v[38:39], v10 offset:50176
    s_waitcnt lgkmcnt(13)
    v_mfma_f32_32x32x16_bf16 v[96:111], v[52:55], v[44:47], v[96:111]
    ds_read_b64_tr_b16 v[40:41], v11 offset:49152
    ds_read_b64_tr_b16 v[42:43], v11 offset:50176
    s_waitcnt lgkmcnt(12)
    v_mfma_f32_32x32x16_bf16 v[80:95], v[60:63], v[56:59], v[80:95]
    ds_read_b128 v[44:47], v7 offset:24576
    ds_read_b64_tr_b16 v[48:49], v10 offset:53248
    ds_read_b64_tr_b16 v[50:51], v10 offset:54272
    s_waitcnt lgkmcnt(13)
    v_mfma_f32_32x32x16_bf16 v[96:111], v[64:67], v[56:59], v[96:111]
    ds_read_b64_tr_b16 v[52:53], v11 offset:53248
    ds_read_b64_tr_b16 v[54:55], v11 offset:54272
    s_waitcnt lgkmcnt(12)
    v_mfma_f32_32x32x16_bf16 v[80:95], v[72:75], v[68:71], v[80:95]
    ds_read_b128 v[56:59], v8 offset:24576
    ds_read_b64_tr_b16 v[60:61], v10 offset:57344
    ds_read_b64_tr_b16 v[62:63], v10 offset:58368
    s_waitcnt lgkmcnt(13)
    v_mfma_f32_32x32x16_bf16 v[96:111], v[76:79], v[68:71], v[96:111]
    ds_read_b64_tr_b16 v[64:65], v11 offset:57344
    ds_read_b64_tr_b16 v[66:67], v11 offset:58368
    s_waitcnt lgkmcnt(12)
    v_mfma_f32_32x32x16_bf16 v[80:95], v[36:39], v[32:35], v[80:95]
    ds_read_b128 v[68:71], v9 offset:24576
    ds_read_b64_tr_b16 v[72:73], v10 offset:61440
    ds_read_b64_tr_b16 v[74:75], v10 offset:62464
    s_waitcnt lgkmcnt(13)
    v_mfma_f32_32x32x16_bf16 v[96:111], v[40:43], v[32:35], v[96:111]
    ds_read_b64_tr_b16 v[76:77], v11 offset:61440
    ds_read_b64_tr_b16 v[78:79], v11 offset:62464
    s_waitcnt lgkmcnt(12)
    v_mfma_f32_32x32x16_bf16 v[80:95], v[48:51], v[44:47], v[80:95]
    s_barrier
    s_mov_b64 exec, 1
    buffer_load_dwordx2 v[30:31], v17, s[32:35], 0 offen sc1
    s_mov_b64 exec, -1
    ds_read_b128 v[32:35], v6 offset:32768
    ds_read_b64_tr_b16 v[36:37], v3 offset:0
    ds_read_b64_tr_b16 v[38:39], v3 offset:1024
    s_waitcnt lgkmcnt(13)
    v_mfma_f32_32x32x16_bf16 v[96:111], v[52:55], v[44:47], v[96:111]
    ds_read_b64_tr_b16 v[40:41], v4 offset:0
    ds_read_b64_tr_b16 v[42:43], v4 offset:1024
    s_waitcnt lgkmcnt(12)
    v_mfma_f32_32x32x16_bf16 v[80:95], v[60:63], v[56:59], v[80:95]
    ds_read_b128 v[44:47], v7 offset:32768
    ds_read_b64_tr_b16 v[48:49], v3 offset:4096
    ds_read_b64_tr_b16 v[50:51], v3 offset:5120
    s_waitcnt lgkmcnt(13)
    v_mfma_f32_32x32x16_bf16 v[96:111], v[64:67], v[56:59], v[96:111]
    ds_read_b64_tr_b16 v[52:53], v4 offset:4096
    ds_read_b64_tr_b16 v[54:55], v4 offset:5120
    s_waitcnt lgkmcnt(12)
    v_mfma_f32_32x32x16_bf16 v[80:95], v[72:75], v[68:71], v[80:95]
    ds_read_b128 v[56:59], v8 offset:32768
    ds_read_b64_tr_b16 v[60:61], v3 offset:8192
    ds_read_b64_tr_b16 v[62:63], v3 offset:9216
    s_waitcnt lgkmcnt(13)
    v_mfma_f32_32x32x16_bf16 v[96:111], v[76:79], v[68:71], v[96:111]
    ds_read_b64_tr_b16 v[64:65], v4 offset:8192
    ds_read_b64_tr_b16 v[66:67], v4 offset:9216
    s_waitcnt lgkmcnt(12)
    v_mfma_f32_32x32x16_bf16 v[80:95], v[36:39], v[32:35], v[80:95]
    ds_read_b128 v[68:71], v9 offset:32768
    ds_read_b64_tr_b16 v[72:73], v3 offset:12288
    ds_read_b64_tr_b16 v[74:75], v3 offset:13312
    s_waitcnt lgkmcnt(13)
    v_mfma_f32_32x32x16_bf16 v[96:111], v[40:43], v[32:35], v[96:111]
    ds_read_b64_tr_b16 v[76:77], v4 offset:12288
    ds_read_b64_tr_b16 v[78:79], v4 offset:13312
    s_waitcnt lgkmcnt(12)
    v_mfma_f32_32x32x16_bf16 v[80:95], v[48:51], v[44:47], v[80:95]
    s_barrier
    ds_read_b128 v[32:35], v6 offset:0
    ds_read_b64_tr_b16 v[36:37], v3 offset:16384
    ds_read_b64_tr_b16 v[38:39], v3 offset:17408
    s_waitcnt lgkmcnt(13)
    v_mfma_f32_32x32x16_bf16 v[96:111], v[52:55], v[44:47], v[96:111]
    ds_read_b64_tr_b16 v[40:41], v4 offset:16384
    ds_read_b64_tr_b16 v[42:43], v4 offset:17408
    s_waitcnt lgkmcnt(12)
    v_mfma_f32_32x32x16_bf16 v[80:95], v[60:63], v[56:59], v[80:95]
    ds_read_b128 v[44:47], v7 offset:0
    ds_read_b64_tr_b16 v[48:49], v3 offset:20480
    ds_read_b64_tr_b16 v[50:51], v3 offset:21504
    s_waitcnt lgkmcnt(13)
    v_mfma_f32_32x32x16_bf16 v[96:111], v[64:67], v[56:59], v[96:111]
    ds_read_b64_tr_b16 v[52:53], v4 offset:20480
    ds_read_b64_tr_b16 v[54:55], v4 offset:21504
    s_waitcnt lgkmcnt(12)
    v_mfma_f32_32x32x16_bf16 v[80:95], v[72:75], v[68:71], v[80:95]
    ds_read_b128 v[56:59], v8 offset:0
    ds_read_b64_tr_b16 v[60:61], v3 offset:24576
    ds_read_b64_tr_b16 v[62:63], v3 offset:25600
    s_waitcnt lgkmcnt(13)
    v_mfma_f32_32x32x16_bf16 v[96:111], v[76:79], v[68:71], v[96:111]
    ds_read_b64_tr_b16 v[64:65], v4 offset:24576
    ds_read_b64_tr_b16 v[66:67], v4 offset:25600
    s_waitcnt lgkmcnt(12)
    v_mfma_f32_32x32x16_bf16 v[80:95], v[36:39], v[32:35], v[80:95]
    ds_read_b128 v[68:71], v9 offset:0
    ds_read_b64_tr_b16 v[72:73], v3 offset:28672
    ds_read_b64_tr_b16 v[74:75], v3 offset:29696
    s_waitcnt lgkmcnt(13)
    v_mfma_f32_32x32x16_bf16 v[96:111], v[40:43], v[32:35], v[96:111]
    ds_read_b64_tr_b16 v[76:77], v4 offset:28672
    ds_read_b64_tr_b16 v[78:79], v4 offset:29696
    s_waitcnt lgkmcnt(12)
    v_mfma_f32_32x32x16_bf16 v[80:95], v[48:51], v[44:47], v[80:95]
    s_barrier
    ds_read_b128 v[32:35], v6 offset:8192
    ds_read_b64_tr_b16 v[36:37], v3 offset:32768
    ds_read_b64_tr_b16 v[38:39], v3 offset:33792
    s_waitcnt lgkmcnt(13)
    v_mfma_f32_32x32x16_bf16 v[96:111], v[52:55], v[44:47], v[96:111]
    ds_read_b64_tr_b16 v[40:41], v4 offset:32768
    ds_read_b64_tr_b16 v[42:43], v4 offset:33792
    s_waitcnt lgkmcnt(12)
    v_mfma_f32_32x32x16_bf16 v[80:95], v[60:63], v[56:59], v[80:95]
    ds_read_b128 v[44:47], v7 offset:8192
    ds_read_b64_tr_b16 v[48:49], v3 offset:36864
    ds_read_b64_tr_b16 v[50:51], v3 offset:37888
    s_waitcnt lgkmcnt(13)
    v_mfma_f32_32x32x16_bf16 v[96:111], v[64:67], v[56:59], v[96:111]
    ds_read_b64_tr_b16 v[52:53], v4 offset:36864
    ds_read_b64_tr_b16 v[54:55], v4 offset:37888
    s_waitcnt lgkmcnt(12)
    v_mfma_f32_32x32x16_bf16 v[80:95], v[72:75], v[68:71], v[80:95]
    ds_read_b128 v[56:59], v8 offset:8192
    ds_read_b64_tr_b16 v[60:61], v3 offset:40960
    ds_read_b64_tr_b16 v[62:63], v3 offset:41984
    s_waitcnt lgkmcnt(13)
    v_mfma_f32_32x32x16_bf16 v[96:111], v[76:79], v[68:71], v[96:111]
    ds_read_b64_tr_b16 v[64:65], v4 offset:40960
    ds_read_b64_tr_b16 v[66:67], v4 offset:41984
    s_waitcnt lgkmcnt(12)
    v_mfma_f32_32x32x16_bf16 v[80:95], v[36:39], v[32:35], v[80:95]
    ds_read_b128 v[68:71], v9 offset:8192
    ds_read_b64_tr_b16 v[72:73], v3 offset:45056
    ds_read_b64_tr_b16 v[74:75], v3 offset:46080
    s_waitcnt lgkmcnt(13)
    v_mfma_f32_32x32x16_bf16 v[96:111], v[40:43], v[32:35], v[96:111]
    ds_read_b64_tr_b16 v[76:77], v4 offset:45056
    ds_read_b64_tr_b16 v[78:79], v4 offset:46080
    s_waitcnt lgkmcnt(12)
    v_mfma_f32_32x32x16_bf16 v[80:95], v[48:51], v[44:47], v[80:95]
    s_waitcnt lgkmcnt(10)
    v_mfma_f32_32x32x16_bf16 v[96:111], v[52:55], v[44:47], v[96:111]
    s_waitcnt lgkmcnt(7)
    v_mfma_f32_32x32x16_bf16 v[80:95], v[60:63], v[56:59], v[80:95]
    s_waitcnt lgkmcnt(0)
    s_barrier
    v_mfma_f32_32x32x16_bf16 v[96:111], v[64:67], v[56:59], v[96:111]
    v_mfma_f32_32x32x16_bf16 v[80:95], v[72:75], v[68:71], v[80:95]
    v_mfma_f32_32x32x16_bf16 v[96:111], v[76:79], v[68:71], v[96:111]
    s_branch L_gelu
L_passk:
    s_barrier
    s_lshl_b32 s50, s45, 7
    s_lshl_b32 s51, s49, 6
    s_add_u32 s50, s50, s51
    s_load_dwordx16 s[68:83], s[28:29], s50
    s_branch L_warm
L_warmb:
    s_barrier
    s_barrier
    s_waitcnt lgkmcnt(0)
    v_mov_b32 v20, s68
    v_mov_b32 v21, s69
    v_mov_b32 v22, s72
    v_mov_b32 v23, s73
    v_mov_b32 v24, s76
    v_mov_b32 v25, s77
    v_mov_b32 v26, s80
    v_mov_b32 v27, s81
    s_mov_b32 exec_lo, 0
    v_mov_b32 v20, s70
    v_mov_b32 v21, s71
    v_mov_b32 v22, s74
    v_mov_b32 v23, s75
    v_mov_b32 v24, s78
    v_mov_b32 v25, s79
    v_mov_b32 v26, s82
    v_mov_b32 v27, s83
    s_mov_b32 exec_lo, -1
    s_barrier
    s_barrier
    s_mov_b64 exec, 1
    buffer_load_dwordx2 v[30:31], v17, s[32:35], 0 offen sc1
    s_mov_b64 exec, -1
    s_barrier
    s_barrier
    s_barrier
    ds_read_b128 v[32:35], v6 offset:16384
    ds_read_b64_tr_b16 v[36:37], v10 offset:0
    ds_read_b64_tr_b16 v[38:39], v10 offset:1024
    ds_read_b64_tr_b16 v[40:41], v11 offset:0
    ds_read_b64_tr_b16 v[42:43], v11 offset:1024
    ds_read_b128 v[44:47], v7 offset:16384
    ds_read_b64_tr_b16 v[48:49], v10 offset:4096
    ds_read_b64_tr_b16 v[50:51], v10 offset:5120
    ds_read_b64_tr_b16 v[52:53], v11 offset:4096
    ds_read_b64_tr_b16 v[54:55], v11 offset:5120
    ds_read_b128 v[56:59], v8 offset:16384
    ds_read_b64_tr_b16 v[60:61], v10 offset:8192
    ds_read_b64_tr_b16 v[62:63], v10 offset:9216
    ds_read_b64_tr_b16 v[64:65], v11 offset:8192
    ds_read_b64_tr_b16 v[66:67], v11 offset:9216
    s_waitcnt lgkmcnt(12)
    v_mfma_f32_32x32x16_bf16 v[80:95], v[36:39], v[32:35], v[80:95]
    ds_read_b128 v[68:71], v9 offset:16384
    ds_read_b64_tr_b16 v[72:73], v10 offset:12288
    ds_read_b64_tr_b16 v[74:75], v10 offset:13312
    s_waitcnt lgkmcnt(13)
    v_mfma_f32_32x32x16_bf16 v[96:111], v[40:43], v[32:35], v[96:111]
    ds_read_b64_tr_b16 v[76:77], v11 offset:12288
    ds_read_b64_tr_b16 v[78:79], v11 offset:13312
    s_waitcnt lgkmcnt(12)
    v_mfma_f32_32x32x16_bf16 v[80:95], v[48:51], v[44:47], v[80:95]
    ds_read_b128 v[32:35], v6 offset:24576
    ds_read_b64_tr_b16 v[36:37], v10 offset:16384
    ds_read_b64_tr_b16 v[38:39], v10 offset:17408
    s_waitcnt lgkmcnt(13)
    v_mfma_f32_32x32x16_bf16 v[96:111], v[52:55], v[44:47], v[96:111]
    ds_read_b64_tr_b16 v[40:41], v11 offset:16384
    ds_read_b64_tr_b16 v[42:43], v11 offset:17408
    s_waitcnt lgkmcnt(12)
    v_mfma_f32_32x32x16_bf16 v[80:95], v[60:63], v[56:59], v[80:95]
    ds_read_b128 v[44:47], v7 offset:24576
    ds_read_b64_tr_b16 v[48:49], v10 offset:20480
    ds_read_b64_tr_b16 v[50:51], v10 offset:21504
    s_waitcnt lgkmcnt(13)
    v_mfma_f32_32x32x16_bf16 v[96:111], v[64:67], v[56:59], v[96:111]
    ds_read_b64_tr_b16 v[52:53], v11 offset:20480
    ds_read_b64_tr_b16 v[54:55], v11 offset:21504
    s_waitcnt lgkmcnt(12)
    v_mfma_f32_32x32x16_bf16 v[80:95], v[72:75], v[68:71], v[80:95]
    ds_read_b128 v[56:59], v8 offset:24576
    ds_read_b64_tr_b16 v[60:61], v10 offset:24576
    ds_read_b64_tr_b16 v[62:63], v10 offset:25600
    s_waitcnt lgkmcnt(13)
    v_mov_b32 v28, 1
    s_mov_b64 exec, 1
    ds_write_b32 v164, v28
    s_mov_b64 exec, -1
    v_mfma_f32_32x32x16_bf16 v[96:111], v[76:79], v[68:71], v[96:111]
    ds_read_b64_tr_b16 v[64:65], v11 offset:24576
    s_waitcnt lgkmcnt(14)
    ds_read_b64_tr_b16 v[66:67], v11 offset:25600
    s_waitcnt lgkmcnt(13)
    v_mfma_f32_32x32x16_bf16 v[80:95], v[36:39], v[32:35], v[80:95]
    ds_read_b128 v[68:71], v9 offset:24576
    ds_read_b64_tr_b16 v[72:73], v10 offset:28672
    s_waitcnt lgkmcnt(14)
    ds_read_b64_tr_b16 v[74:75], v10 offset:29696
    s_waitcnt lgkmcnt(14)
    v_mfma_f32_32x32x16_bf16 v[96:111], v[40:43], v[32:35], v[96:111]
    ds_read_b64_tr_b16 v[76:77], v11 offset:28672
    s_waitcnt lgkmcnt(14)
    ds_read_b64_tr_b16 v[78:79], v11 offset:29696
    s_waitcnt lgkmcnt(13)
    v_mfma_f32_32x32x16_bf16 v[80:95], v[48:51], v[44:47], v[80:95]
    ds_read_b128 v[32:35], v6 offset:32768
    ds_read_b64_tr_b16 v[36:37], v10 offset:32768
    s_waitcnt lgkmcnt(14)
    ds_read_b64_tr_b16 v[38:39], v10 offset:33792
    s_waitcnt lgkmcnt(14)
    v_mfma_f32_32x32x16_bf16 v[96:111], v[52:55], v[44:47], v[96:111]
    ds_read_b64_tr_b16 v[40:41], v11 offset:32768
    s_waitcnt lgkmcnt(14)
    ds_read_b64_tr_b16 v[42:43], v11 offset:33792
    s_waitcnt lgkmcnt(13)
    v_mfma_f32_32x32x16_bf16 v[80:95], v[60:63], v[56:59], v[80:95]
    ds_read_b128 v[44:47], v7 offset:32768
    ds_read_b64_tr_b16 v[48:49], v10 offset:36864
    s_waitcnt lgkmcnt(14)
    ds_read_b64_tr_b16 v[50:51], v10 offset:37888
    s_waitcnt lgkmcnt(13)
    v_mfma_f32_32x32x16_bf16 v[96:111], v[64:67], v[56:59], v[96:111]
    ds_read_b64_tr_b16 v[52:53], v11 offset:36864
    ds_read_b64_tr_b16 v[54:55], v11 offset:37888
    s_waitcnt lgkmcnt(12)
    v_mfma_f32_32x32x16_bf16 v[80:95], v[72:75], v[68:71], v[80:95]
    ds_read_b128 v[56:59], v8 offset:32768
    ds_read_b64_tr_b16 v[60:61], v10 offset:40960
    ds_read_b64_tr_b16 v[62:63], v10 offset:41984
    s_waitcnt lgkmcnt(14)
    ds_read_b32 v144, v19 offset:32
    s_waitcnt lgkmcnt(14)
    v_mov_b32 v28, 2
    s_mov_b64 exec, 1
    ds_write_b32 v164, v28
    s_mov_b64 exec, -1
    v_mfma_f32_32x32x16_bf16 v[96:111], v[76:79], v[68:71], v[96:111]
    s_waitcnt lgkmcnt(14)
    ds_read_b64_tr_b16 v[64:65], v11 offset:40960
    s_waitcnt lgkmcnt(14)
    ds_read_b64_tr_b16 v[66:67], v11 offset:41984
    s_waitcnt lgkmcnt(14)
    v_mfma_f32_32x32x16_bf16 v[80:95], v[36:39], v[32:35], v[80:95]
    ds_read_b128 v[68:71], v9 offset:32768
    s_waitcnt lgkmcnt(14)
    ds_read_b64_tr_b16 v[72:73], v10 offset:45056
    s_waitcnt lgkmcnt(14)
    ds_read_b64_tr_b16 v[74:75], v10 offset:46080
    v_mfma_f32_32x32x16_bf16 v[96:111], v[40:43], v[32:35], v[96:111]
    s_waitcnt lgkmcnt(14)
    ds_read_b64_tr_b16 v[76:77], v11 offset:45056
    s_waitcnt lgkmcnt(14)
    ds_read_b64_tr_b16 v[78:79], v11 offset:46080
    s_waitcnt lgkmcnt(14)
    v_mfma_f32_32x32x16_bf16 v[80:95], v[48:51], v[44:47], v[80:95]
    s_waitcnt lgkmcnt(8)
    v_cmp_gt_u32 vcc, 1, v144
    s_cbranch_vccnz L_ks3
L_kb3:
    ds_read_b128 v[32:35], v6 offset:0
    ds_read_b64_tr_b16 v[36:37], v10 offset:49152
    ds_read_b64_tr_b16 v[38:39], v10 offset:50176
    v_mfma_f32_32x32x16_bf16 v[96:111], v[52:55], v[44:47], v[96:111]
    ds_read_b64_tr_b16 v[40:41], v11 offset:49152
    ds_read_b64_tr_b16 v[42:43], v11 offset:50176
    v_mfma_f32_32x32x16_bf16 v[80:95], v[60:63], v[56:59], v[80:95]
    ds_read_b128 v[44:47], v7 offset:0
    ds_read_b64_tr_b16 v[48:49], v10 offset:53248
    s_waitcnt lgkmcnt(14)
    ds_read_b64_tr_b16 v[50:51], v10 offset:54272
    s_waitcnt lgkmcnt(13)
    v_mfma_f32_32x32x16_bf16 v[96:111], v[64:67], v[56:59], v[96:111]
    ds_read_b64_tr_b16 v[52:53], v11 offset:53248
    ds_read_b64_tr_b16 v[54:55], v11 offset:54272
    s_waitcnt lgkmcnt(12)
    v_mfma_f32_32x32x16_bf16 v[80:95], v[72:75], v[68:71], v[80:95]
    ds_read_b128 v[56:59], v8 offset:0
    ds_read_b64_tr_b16 v[60:61], v10 offset:57344
    ds_read_b64_tr_b16 v[62:63], v10 offset:58368
    s_waitcnt lgkmcnt(13)
    v_mov_b32 v28, 3
    s_mov_b64 exec, 1
    ds_write_b32 v164, v28
    s_mov_b64 exec, -1
    v_mfma_f32_32x32x16_bf16 v[96:111], v[76:79], v[68:71], v[96:111]
    ds_read_b64_tr_b16 v[64:65], v11 offset:57344
    s_waitcnt lgkmcnt(14)
    ds_read_b64_tr_b16 v[66:67], v11 offset:58368
    s_waitcnt lgkmcnt(13)
    v_mfma_f32_32x32x16_bf16 v[80:95], v[36:39], v[32:35], v[80:95]
    ds_read_b128 v[68:71], v9 offset:0
    ds_read_b64_tr_b16 v[72:73], v10 offset:61440
    s_waitcnt lgkmcnt(14)
    ds_read_b64_tr_b16 v[74:75], v10 offset:62464
    s_waitcnt lgkmcnt(14)
    v_mfma_f32_32x32x16_bf16 v[96:111], v[40:43], v[32:35], v[96:111]
    ds_read_b64_tr_b16 v[76:77], v11 offset:61440
    s_waitcnt lgkmcnt(14)
    ds_read_b64_tr_b16 v[78:79], v11 offset:62464
    s_waitcnt lgkmcnt(13)
    v_mfma_f32_32x32x16_bf16 v[80:95], v[48:51], v[44:47], v[80:95]
    ds_read_b128 v[32:35], v6 offset:8192
    ds_read_b64_tr_b16 v[36:37], v3 offset:0
    s_waitcnt lgkmcnt(14)
    ds_read_b64_tr_b16 v[38:39], v3 offset:1024
    s_waitcnt lgkmcnt(14)
    v_mfma_f32_32x32x16_bf16 v[96:111], v[52:55], v[44:47], v[96:111]
    ds_read_b64_tr_b16 v[40:41], v4 offset:0
    s_waitcnt lgkmcnt(14)
    ds_read_b64_tr_b16 v[42:43], v4 offset:1024
    s_waitcnt lgkmcnt(13)
    v_mfma_f32_32x32x16_bf16 v[80:95], v[60:63], v[56:59], v[80:95]
    ds_read_b128 v[44:47], v7 offset:8192
    ds_read_b64_tr_b16 v[48:49], v3 offset:4096
    s_waitcnt lgkmcnt(14)
    ds_read_b64_tr_b16 v[50:51], v3 offset:5120
    s_waitcnt lgkmcnt(13)
    v_mfma_f32_32x32x16_bf16 v[96:111], v[64:67], v[56:59], v[96:111]
    ds_read_b64_tr_b16 v[52:53], v4 offset:4096
    ds_read_b64_tr_b16 v[54:55], v4 offset:5120
    s_waitcnt lgkmcnt(12)
    v_mfma_f32_32x32x16_bf16 v[80:95], v[72:75], v[68:71], v[80:95]
    ds_read_b128 v[56:59], v8 offset:8192
    ds_read_b64_tr_b16 v[60:61], v3 offset:8192
    ds_read_b64_tr_b16 v[62:63], v3 offset:9216
    s_waitcnt lgkmcnt(14)
    ds_read_b32 v144, v19 offset:32
    s_waitcnt lgkmcnt(14)
    v_mov_b32 v28, 4
    s_mov_b64 exec, 1
    ds_write_b32 v164, v28
    s_mov_b64 exec, -1
    v_mfma_f32_32x32x16_bf16 v[96:111], v[76:79], v[68:71], v[96:111]
    s_waitcnt lgkmcnt(14)
    ds_read_b64_tr_b16 v[64:65], v4 offset:8192
    s_waitcnt lgkmcnt(14)
    ds_read_b64_tr_b16 v[66:67], v4 offset:9216
    s_waitcnt lgkmcnt(14)
    v_mfma_f32_32x32x16_bf16 v[80:95], v[36:39], v[32:35], v[80:95]
    ds_read_b128 v[68:71], v9 offset:8192
    s_waitcnt lgkmcnt(14)
    ds_read_b64_tr_b16 v[72:73], v3 offset:12288
    s_waitcnt lgkmcnt(14)
    ds_read_b64_tr_b16 v[74:75], v3 offset:13312
    v_mfma_f32_32x32x16_bf16 v[96:111], v[40:43], v[32:35], v[96:111]
    s_waitcnt lgkmcnt(14)
    ds_read_b64_tr_b16 v[76:77], v4 offset:12288
    s_waitcnt lgkmcnt(14)
    ds_read_b64_tr_b16 v[78:79], v4 offset:13312
    s_waitcnt lgkmcnt(14)
    v_mfma_f32_32x32x16_bf16 v[80:95], v[48:51], v[44:47], v[80:95]
    s_waitcnt lgkmcnt(8)
    v_cmp_gt_u32 vcc, 2, v144
    s_cbranch_vccnz L_ks5
L_kb5:
    ds_read_b128 v[32:35], v6 offset:16384
    ds_read_b64_tr_b16 v[36:37], v3 offset:16384
    ds_read_b64_tr_b16 v[38:39], v3 offset:17408
    v_mfma_f32_32x32x16_bf16 v[96:111], v[52:55], v[44:47], v[96:111]
    ds_read_b64_tr_b16 v[40:41], v4 offset:16384
    ds_read_b64_tr_b16 v[42:43], v4 offset:17408
    v_mfma_f32_32x32x16_bf16 v[80:95], v[60:63], v[56:59], v[80:95]
    ds_read_b128 v[44:47], v7 offset:16384
    ds_read_b64_tr_b16 v[48:49], v3 offset:20480
    s_waitcnt lgkmcnt(14)
    ds_read_b64_tr_b16 v[50:51], v3 offset:21504
    s_waitcnt lgkmcnt(13)
    v_mfma_f32_32x32x16_bf16 v[96:111], v[64:67], v[56:59], v[96:111]
    ds_read_b64_tr_b16 v[52:53], v4 offset:20480
    ds_read_b64_tr_b16 v[54:55], v4 offset:21504
    s_waitcnt lgkmcnt(12)
    v_mfma_f32_32x32x16_bf16 v[80:95], v[72:75], v[68:71], v[80:95]
    ds_read_b128 v[56:59], v8 offset:16384
    ds_read_b64_tr_b16 v[60:61], v3 offset:24576
    ds_read_b64_tr_b16 v[62:63], v3 offset:25600
    s_waitcnt lgkmcnt(13)
    v_mov_b32 v28, 5
    s_mov_b64 exec, 1
    ds_write_b32 v164, v28
    s_mov_b64 exec, -1
    v_mfma_f32_32x32x16_bf16 v[96:111], v[76:79], v[68:71], v[96:111]
    ds_read_b64_tr_b16 v[64:65], v4 offset:24576
    s_waitcnt lgkmcnt(14)
    ds_read_b64_tr_b16 v[66:67], v4 offset:25600
    s_waitcnt lgkmcnt(13)
    v_mfma_f32_32x32x16_bf16 v[80:95], v[36:39], v[32:35], v[80:95]
    ds_read_b128 v[68:71], v9 offset:16384
    ds_read_b64_tr_b16 v[72:73], v3 offset:28672
    s_waitcnt lgkmcnt(14)
    ds_read_b64_tr_b16 v[74:75], v3 offset:29696
    s_waitcnt lgkmcnt(14)
    v_mfma_f32_32x32x16_bf16 v[96:111], v[40:43], v[32:35], v[96:111]
    ds_read_b64_tr_b16 v[76:77], v4 offset:28672
    s_waitcnt lgkmcnt(14)
    ds_read_b64_tr_b16 v[78:79], v4 offset:29696
    s_waitcnt lgkmcnt(13)
    v_mfma_f32_32x32x16_bf16 v[80:95], v[48:51], v[44:47], v[80:95]
    ds_read_b128 v[32:35], v6 offset:24576
    ds_read_b64_tr_b16 v[36:37], v3 offset:32768
    s_waitcnt lgkmcnt(14)
    ds_read_b64_tr_b16 v[38:39], v3 offset:33792
    s_waitcnt lgkmcnt(14)
    v_mfma_f32_32x32x16_bf16 v[96:111], v[52:55], v[44:47], v[96:111]
    ds_read_b64_tr_b16 v[40:41], v4 offset:32768
    s_waitcnt lgkmcnt(14)
    ds_read_b64_tr_b16 v[42:43], v4 offset:33792
    s_waitcnt lgkmcnt(13)
    v_mfma_f32_32x32x16_bf16 v[80:95], v[60:63], v[56:59], v[80:95]
    ds_read_b128 v[44:47], v7 offset:24576
    ds_read_b64_tr_b16 v[48:49], v3 offset:36864
    s_waitcnt lgkmcnt(14)
    ds_read_b64_tr_b16 v[50:51], v3 offset:37888
    s_waitcnt lgkmcnt(13)
    v_mfma_f32_32x32x16_bf16 v[96:111], v[64:67], v[56:59], v[96:111]
    ds_read_b64_tr_b16 v[52:53], v4 offset:36864
    ds_read_b64_tr_b16 v[54:55], v4 offset:37888
    s_waitcnt lgkmcnt(12)
    v_mfma_f32_32x32x16_bf16 v[80:95], v[72:75], v[68:71], v[80:95]
    ds_read_b128 v[56:59], v8 offset:24576
    ds_read_b64_tr_b16 v[60:61], v3 offset:40960
    ds_read_b64_tr_b16 v[62:63], v3 offset:41984
    s_waitcnt lgkmcnt(13)
    v_mov_b32 v28, 6
    s_mov_b64 exec, 1
    ds_write_b32 v164, v28
    s_mov_b64 exec, -1
    v_mfma_f32_32x32x16_bf16 v[96:111], v[76:79], v[68:71], v[96:111]
    ds_read_b64_tr_b16 v[64:65], v4 offset:40960
    s_waitcnt lgkmcnt(14)
    ds_read_b64_tr_b16 v[66:67], v4 offset:41984
    s_waitcnt lgkmcnt(13)
    v_mfma_f32_32x32x16_bf16 v[80:95], v[36:39], v[32:35], v[80:95]
    ds_read_b128 v[68:71], v9 offset:24576
    ds_read_b64_tr_b16 v[72:73], v3 offset:45056
    s_waitcnt lgkmcnt(14)
    ds_read_b64_tr_b16 v[74:75], v3 offset:46080
    s_waitcnt lgkmcnt(14)
    v_mfma_f32_32x32x16_bf16 v[96:111], v[40:43], v[32:35], v[96:111]
    ds_read_b64_tr_b16 v[76:77], v4 offset:45056
    s_waitcnt lgkmcnt(14)
    ds_read_b64_tr_b16 v[78:79], v4 offset:46080
    s_waitcnt lgkmcnt(13)
    v_mfma_f32_32x32x16_bf16 v[80:95], v[48:51], v[44:47], v[80:95]
    s_waitcnt lgkmcnt(11)
    v_mfma_f32_32x32x16_bf16 v[96:111], v[52:55], v[44:47], v[96:111]
    s_waitcnt lgkmcnt(8)
    v_mfma_f32_32x32x16_bf16 v[80:95], v[60:63], v[56:59], v[80:95]
    s_waitcnt lgkmcnt(5)
    v_mfma_f32_32x32x16_bf16 v[96:111], v[64:67], v[56:59], v[96:111]
    s_waitcnt lgkmcnt(2)
    v_mfma_f32_32x32x16_bf16 v[80:95], v[72:75], v[68:71], v[80:95]
    s_waitcnt lgkmcnt(0)
    v_mov_b32 v28, 7
    s_mov_b64 exec, 1
    ds_write_b32 v164, v28
    s_mov_b64 exec, -1
    v_mfma_f32_32x32x16_bf16 v[96:111], v[76:79], v[68:71], v[96:111]
L_gelu:
    s_setprio 0
    v_mov_b32 v48, s57
    s_nop 7
    s_nop 2
    v_mul_f32 v32, v80, v80
    v_mul_f32 v33, v81, v81
    v_mul_f32 v34, v82, v82
    v_mul_f32 v35, v83, v83
    v_mul_f32 v36, v84, v84
    v_mul_f32 v37, v85, v85
    v_mul_f32 v38, v86, v86
    v_mul_f32 v39, v87, v87
    v_fma_f32 v32, v32, s56, v48
    v_fma_f32 v33, v33, s56, v48
    v_fma_f32 v34, v34, s56, v48
    v_fma_f32 v35, v35, s56, v48
    v_fma_f32 v36, v36, s56, v48
    v_fma_f32 v37, v37, s56, v48
    v_fma_f32 v38, v38, s56, v48
    v_fma_f32 v39, v39, s56, v48
    v_mul_f32 v32, v32, v80
    v_mul_f32 v33, v33, v81
    v_mul_f32 v34, v34, v82
    v_mul_f32 v35, v35, v83
    v_mul_f32 v36, v36, v84
    v_mul_f32 v37, v37, v85
    v_mul_f32 v38, v38, v86
    v_mul_f32 v39, v39, v87
    v_exp_f32 v32, v32
    v_exp_f32 v33, v33
    v_exp_f32 v34, v34
    v_exp_f32 v35, v35
    v_exp_f32 v36, v36
    v_exp_f32 v37, v37
    v_exp_f32 v38, v38
    v_exp_f32 v39, v39
    v_add_f32 v32, 1.0, v32
    v_add_f32 v33, 1.0, v33
    v_add_f32 v34, 1.0, v34
    v_add_f32 v35, 1.0, v35
    v_add_f32 v36, 1.0, v36
    v_add_f32 v37, 1.0, v37
    v_add_f32 v38, 1.0, v38
    v_add_f32 v39, 1.0, v39
    v_rcp_f32 v32, v32
    v_rcp_f32 v33, v33
    v_rcp_f32 v34, v34
    v_rcp_f32 v35, v35
    v_rcp_f32 v36, v36
    v_rcp_f32 v37, v37
    v_rcp_f32 v38, v38
    v_rcp_f32 v39, v39
    v_mul_f32 v32, v32, v80
    v_mul_f32 v33, v33, v81
    v_mul_f32 v34, v34, v82
    v_mul_f32 v35, v35, v83
    v_mul_f32 v36, v36, v84
    v_mul_f32 v37, v37, v85
    v_mul_f32 v38, v38, v86
    v_mul_f32 v39, v39, v87
    v_cvt_pk_bf16_f32 v112, v32, v33
    v_cvt_pk_bf16_f32 v113, v34, v35
    v_cvt_pk_bf16_f32 v114, v36, v37
    v_cvt_pk_bf16_f32 v115, v38, v39
    v_mul_f32 v40, v88, v88
    v_mul_f32 v41, v89, v89
    v_mul_f32 v42, v90, v90
    v_mul_f32 v43, v91, v91
    v_mul_f32 v44, v92, v92
    v_mul_f32 v45, v93, v93
    v_mul_f32 v46, v94, v94
    v_mul_f32 v47, v95, v95
    v_fma_f32 v40, v40, s56, v48
    v_fma_f32 v41, v41, s56, v48
    v_fma_f32 v42, v42, s56, v48
    v_fma_f32 v43, v43, s56, v48
    v_fma_f32 v44, v44, s56, v48
    v_fma_f32 v45, v45, s56, v48
    v_fma_f32 v46, v46, s56, v48
    v_fma_f32 v47, v47, s56, v48
    v_mul_f32 v40, v40, v88
    v_mul_f32 v41, v41, v89
    v_mul_f32 v42, v42, v90
    v_mul_f32 v43, v43, v91
    v_mul_f32 v44, v44, v92
    v_mul_f32 v45, v45, v93
    v_mul_f32 v46, v46, v94
    v_mul_f32 v47, v47, v95
    v_exp_f32 v40, v40
    v_exp_f32 v41, v41
    v_exp_f32 v42, v42
    v_exp_f32 v43, v43
    v_exp_f32 v44, v44
    v_exp_f32 v45, v45
    v_exp_f32 v46, v46
    v_exp_f32 v47, v47
    v_add_f32 v40, 1.0, v40
    v_add_f32 v41, 1.0, v41
    v_add_f32 v42, 1.0, v42
    v_add_f32 v43, 1.0, v43
    v_add_f32 v44, 1.0, v44
    v_add_f32 v45, 1.0, v45
    v_add_f32 v46, 1.0, v46
    v_add_f32 v47, 1.0, v47
    v_rcp_f32 v40, v40
    v_rcp_f32 v41, v41
    v_rcp_f32 v42, v42
    v_rcp_f32 v43, v43
    v_rcp_f32 v44, v44
    v_rcp_f32 v45, v45
    v_rcp_f32 v46, v46
    v_rcp_f32 v47, v47
    v_mul_f32 v40, v40, v88
    v_mul_f32 v41, v41, v89
    v_mul_f32 v42, v42, v90
    v_mul_f32 v43, v43, v91
    v_mul_f32 v44, v44, v92
    v_mul_f32 v45, v45, v93
    v_mul_f32 v46, v46, v94
    v_mul_f32 v47, v47, v95
    v_cvt_pk_bf16_f32 v116, v40, v41
    v_cvt_pk_bf16_f32 v117, v42, v43
    v_cvt_pk_bf16_f32 v118, v44, v45
    v_cvt_pk_bf16_f32 v119, v46, v47
    v_mul_f32 v32, v96, v96
    v_mul_f32 v33, v97, v97
    v_mul_f32 v34, v98, v98
    v_mul_f32 v35, v99, v99
    v_mul_f32 v36, v100, v100
    v_mul_f32 v37, v101, v101
    v_mul_f32 v38, v102, v102
    v_mul_f32 v39, v103, v103
    v_fma_f32 v32, v32, s56, v48
    v_fma_f32 v33, v33, s56, v48
    v_fma_f32 v34, v34, s56, v48
    v_fma_f32 v35, v35, s56, v48
    v_fma_f32 v36, v36, s56, v48
    v_fma_f32 v37, v37, s56, v48
    v_fma_f32 v38, v38, s56, v48
    v_fma_f32 v39, v39, s56, v48
    v_mul_f32 v32, v32, v96
    v_mul_f32 v33, v33, v97
    v_mul_f32 v34, v34, v98
    v_mul_f32 v35, v35, v99
    v_mul_f32 v36, v36, v100
    v_mul_f32 v37, v37, v101
    v_mul_f32 v38, v38, v102
    v_mul_f32 v39, v39, v103
    v_exp_f32 v32, v32
    v_exp_f32 v33, v33
    v_exp_f32 v34, v34
    v_exp_f32 v35, v35
    v_exp_f32 v36, v36
    v_exp_f32 v37, v37
    v_exp_f32 v38, v38
    v_exp_f32 v39, v39
    v_add_f32 v32, 1.0, v32
    v_add_f32 v33, 1.0, v33
    v_add_f32 v34, 1.0, v34
    v_add_f32 v35, 1.0, v35
    v_add_f32 v36, 1.0, v36
    v_add_f32 v37, 1.0, v37
    v_add_f32 v38, 1.0, v38
    v_add_f32 v39, 1.0, v39
    v_rcp_f32 v32, v32
    v_rcp_f32 v33, v33
    v_rcp_f32 v34, v34
    v_rcp_f32 v35, v35
    v_rcp_f32 v36, v36
    v_rcp_f32 v37, v37
    v_rcp_f32 v38, v38
    v_rcp_f32 v39, v39
    v_mul_f32 v32, v32, v96
    v_mul_f32 v33, v33, v97
    v_mul_f32 v34, v34, v98
    v_mul_f32 v35, v35, v99
    v_mul_f32 v36, v36, v100
    v_mul_f32 v37, v37, v101
    v_mul_f32 v38, v38, v102
    v_mul_f32 v39, v39, v103
    v_cvt_pk_bf16_f32 v120, v32, v33
    v_cvt_pk_bf16_f32 v121, v34, v35
    v_cvt_pk_bf16_f32 v122, v36, v37
    v_cvt_pk_bf16_f32 v123, v38, v39
    v_mul_f32 v40, v104, v104
    v_mul_f32 v41, v105, v105
    v_mul_f32 v42, v106, v106
    v_mul_f32 v43, v107, v107
    v_mul_f32 v44, v108, v108
    v_mul_f32 v45, v109, v109
    v_mul_f32 v46, v110, v110
    v_mul_f32 v47, v111, v111
    v_fma_f32 v40, v40, s56, v48
    v_fma_f32 v41, v41, s56, v48
    v_fma_f32 v42, v42, s56, v48
    v_fma_f32 v43, v43, s56, v48
    v_fma_f32 v44, v44, s56, v48
    v_fma_f32 v45, v45, s56, v48
    v_fma_f32 v46, v46, s56, v48
    v_fma_f32 v47, v47, s56, v48
    v_mul_f32 v40, v40, v104
    v_mul_f32 v41, v41, v105
    v_mul_f32 v42, v42, v106
    v_mul_f32 v43, v43, v107
    v_mul_f32 v44, v44, v108
    v_mul_f32 v45, v45, v109
    v_mul_f32 v46, v46, v110
    v_mul_f32 v47, v47, v111
    v_exp_f32 v40, v40
    v_exp_f32 v41, v41
    v_exp_f32 v42, v42
    v_exp_f32 v43, v43
    v_exp_f32 v44, v44
    v_exp_f32 v45, v45
    v_exp_f32 v46, v46
    v_exp_f32 v47, v47
    v_add_f32 v40, 1.0, v40
    v_add_f32 v41, 1.0, v41
    v_add_f32 v42, 1.0, v42
    v_add_f32 v43, 1.0, v43
    v_add_f32 v44, 1.0, v44
    v_add_f32 v45, 1.0, v45
    v_add_f32 v46, 1.0, v46
    v_add_f32 v47, 1.0, v47
    v_rcp_f32 v40, v40
    v_rcp_f32 v41, v41
    v_rcp_f32 v42, v42
    v_rcp_f32 v43, v43
    v_rcp_f32 v44, v44
    v_rcp_f32 v45, v45
    v_rcp_f32 v46, v46
    v_rcp_f32 v47, v47
    v_mul_f32 v40, v40, v104
    v_mul_f32 v41, v41, v105
    v_mul_f32 v42, v42, v106
    v_mul_f32 v43, v43, v107
    v_mul_f32 v44, v44, v108
    v_mul_f32 v45, v45, v109
    v_mul_f32 v46, v46, v110
    v_mul_f32 v47, v47, v111
    v_cvt_pk_bf16_f32 v124, v40, v41
    v_cvt_pk_bf16_f32 v125, v42, v43
    v_cvt_pk_bf16_f32 v126, v44, v45
    v_cvt_pk_bf16_f32 v127, v46, v47
    buffer_store_dwordx4 v[112:115], v18, s[16:19], s46 offen offset:0 sc1
    buffer_store_dwordx4 v[116:119], v18, s[16:19], s46 offen offset:1024 sc1
    buffer_store_dwordx4 v[120:123], v18, s[16:19], s46 offen offset:2048 sc1
    buffer_store_dwordx4 v[124:127], v18, s[16:19], s46 offen offset:3072 sc1
    s_mov_b32 s22, 1835008
    s_mov_b32 s23, 0x20000
    s_lshl_b32 s50, s49, 6
    v_xor_b32 v12, s50, v12
    v_xor_b32 v13, 64, v12
    v_add_u32 v10, 65536, v12
    v_add_u32 v11, 65536, v13
    v_xor_b32 v16, 8, v17
    v_min_u32 v160, 6, v0
    v_lshlrev_b32 v161, 3, v160
    v_lshlrev_b32 v160, 7, v160
    s_lshl_b32 s38, s40, 2
    s_add_u32 s38, s38, s44
    s_lshl_b32 s47, s38, 9
    s_lshl_b32 s50, s3, 6
    s_add_u32 s47, s47, s50
    s_lshl_b32 s39, s47, 4
    s_add_u32 s39, s39, 8650752
    s_add_u32 s47, s47, 8388608
    s_lshl_b32 s50, s45, 3
    s_add_u32 s58, s47, s50
    s_lshl_b32 s50, s45, 7
    s_add_u32 s37, s39, s50
    s_lshl_b32 s51, s3, 12
    v_add_u32 v162, s51, v14
    v_xor_b32 v163, 8192, v162
    v_xor_b32 v165, 8, v164
    s_lshl_b32 s51, s94, 13
    v_mov_b32 v167, 1
    s_lshl_b32 s95, s2, 15
    s_add_u32 s95, s95, s51
    s_add_u32 s95, s95, 9437184
    s_lshl_b32 s50, s42, 7
    s_lshl_b32 s51, s36, 6
    s_add_u32 s50, s50, s51
    s_lshl_b32 s51, s48, 5
    s_add_u32 s50, s50, s51
    v_add_u32 v6, s50, v1
    v_mul_u32_u24 v6, 896, v6
    v_lshl_add_u32 v6, v2, 4, v6
    s_lshl_b32 s50, s45, 7
    s_lshl_b32 s51, s49, 6
    s_add_u32 s50, s50, s51
    v_add_u32 v6, s50, v6
    s_mov_b32 s54, s45
    v_lshlrev_b32 v80, 16, v20
    v_and_b32 v81, 0xffff0000, v20
    v_lshlrev_b32 v82, 16, v21
    v_and_b32 v83, 0xffff0000, v21
    v_lshlrev_b32 v84, 16, v22
    v_and_b32 v85, 0xffff0000, v22
    v_lshlrev_b32 v86, 16, v23
    v_and_b32 v87, 0xffff0000, v23
    v_lshlrev_b32 v88, 16, v24
    v_and_b32 v89, 0xffff0000, v24
    v_lshlrev_b32 v90, 16, v25
    v_and_b32 v91, 0xffff0000, v25
    v_lshlrev_b32 v92, 16, v26
    v_and_b32 v93, 0xffff0000, v26
    v_lshlrev_b32 v94, 16, v27
    v_and_b32 v95, 0xffff0000, v27
    s_add_u32 s54, s54, 1
    s_cmp_eq_u32 s54, 7
    s_cselect_b32 s54, 0, s54
    s_lshl_b32 s96, s54, 13
    s_add_u32 s54, s54, 1
    s_cmp_eq_u32 s54, 7
    s_cselect_b32 s54, 0, s54
    s_lshl_b32 s97, s54, 13
    s_add_u32 s54, s54, 1
    s_cmp_eq_u32 s54, 7
    s_cselect_b32 s54, 0, s54
    s_lshl_b32 s98, s54, 13
    s_add_u32 s54, s54, 1
    s_cmp_eq_u32 s54, 7
    s_cselect_b32 s54, 0, s54
    s_lshl_b32 s99, s54, 13
    s_add_u32 s54, s54, 1
    s_cmp_eq_u32 s54, 7
    s_cselect_b32 s54, 0, s54
    s_lshl_b32 s100, s54, 13
    s_add_u32 s54, s54, 1
    s_cmp_eq_u32 s54, 7
    s_cselect_b32 s54, 0, s54
    s_lshl_b32 s101, s54, 13
    s_waitcnt vmcnt(0)
L_tg:
    v_readfirstlane_b32 s52, v30
    v_readfirstlane_b32 s53, v31
    s_add_u32 s59, s59, 1
    s_cmp_lg_u32 s52, 0
    s_cbranch_scc1 L_tgok
    s_cmp_gt_u32 s59, 262144
    s_cbranch_scc1 L_tgok
    buffer_load_dwordx2 v[30:31], v17, s[32:35], 0 offen sc1
    s_waitcnt vmcnt(0)
    s_branch L_tg
L_tgok:
    s_mov_b64 exec, 1
    buffer_store_dwordx2 v[30:31], v5, s[16:19], s58 offen
    s_mov_b64 exec, 127
    s_mov_b64 s[56:57], -1
    s_mov_b32 s55, 0
L_poll:
    s_add_u32 s55, s55, 1
    s_cmp_gt_u32 s55, 40
    s_cbranch_scc1 L_pollg
L_polll:
    buffer_load_dwordx2 v[28:29], v161, s[16:19], s47 offen sc1
L_pollw:
    s_waitcnt vmcnt(0)
    v_cmp_ne_u64 vcc, s[52:53], v[28:29]
    s_cmp_gt_u32 s55, 262144
    s_cbranch_scc1 L_pollok
    s_and_b64 s[56:57], s[56:57], vcc
    s_cbranch_scc0 L_pollok
    s_sleep 1
    s_branch L_poll
L_pollg:
    s_bitcmp1_b32 s55, 0
    s_cbranch_scc1 L_polll
    s_mov_b64 exec, 1
    buffer_store_dwordx2 v[30:31], v5, s[16:19], s37 offen sc1
    s_mov_b64 exec, 127
    buffer_load_dwordx2 v[28:29], v160, s[16:19], s39 offen sc1
    s_branch L_pollw
L_pollok:
    s_mov_b64 exec, -1
    buffer_load_dwordx4 v[128:131], v18, s[16:19], s96 offen offset:0 sc1
    buffer_load_dwordx4 v[132:135], v18, s[16:19], s96 offen offset:1024 sc1
    buffer_load_dwordx4 v[136:139], v18, s[16:19], s96 offen offset:2048 sc1
    buffer_load_dwordx4 v[140:143], v18, s[16:19], s96 offen offset:3072 sc1
    buffer_load_dwordx4 v[144:147], v18, s[16:19], s97 offen offset:0 sc1
    buffer_load_dwordx4 v[148:151], v18, s[16:19], s97 offen offset:1024 sc1
    buffer_load_dwordx4 v[152:155], v18, s[16:19], s97 offen offset:2048 sc1
    buffer_load_dwordx4 v[156:159], v18, s[16:19], s97 offen offset:3072 sc1
L_cw2:
    ds_read_b32 v76, v19 offset:32
    s_add_u32 s59, s59, 1
    s_waitcnt lgkmcnt(0)
    v_cmp_gt_u32 vcc, 3, v76
    s_cmp_gt_u32 s59, 262144
    s_cbranch_scc1 L_cw2ok
    s_cbranch_vccz L_cw2ok
    s_sleep 1
    s_branch L_cw2
L_cw2ok:
    ds_read_b32 v76, v19 offset:32
    ds_read_b64_tr_b16 v[32:33], v12 offset:0
    ds_read_b64_tr_b16 v[34:35], v12 offset:1024
    ds_read_b64_tr_b16 v[36:37], v13 offset:0
    ds_read_b64_tr_b16 v[38:39], v13 offset:1024
    ds_read_b64_tr_b16 v[40:41], v12 offset:2048
    ds_read_b64_tr_b16 v[42:43], v12 offset:3072
    ds_read_b64_tr_b16 v[44:45], v13 offset:2048
    ds_read_b64_tr_b16 v[46:47], v13 offset:3072
    ds_read_b64_tr_b16 v[48:49], v12 offset:4096
    ds_read_b64_tr_b16 v[50:51], v12 offset:5120
    ds_read_b64_tr_b16 v[52:53], v13 offset:4096
    ds_read_b64_tr_b16 v[54:55], v13 offset:5120
    s_waitcnt vmcnt(11) lgkmcnt(10)
    v_mfma_f32_32x32x16_bf16 v[80:95], v[32:35], v[112:115], v[80:95]
    ds_read_b64_tr_b16 v[56:57], v12 offset:6144
    ds_read_b64_tr_b16 v[58:59], v12 offset:7168
    s_waitcnt lgkmcnt(10)
    v_mfma_f32_32x32x16_bf16 v[96:111], v[36:39], v[112:115], 0
    buffer_load_dwordx4 v[112:115], v18, s[16:19], s98 offen offset:0 sc1
    ds_read_b64_tr_b16 v[60:61], v13 offset:6144
    ds_read_b64_tr_b16 v[62:63], v13 offset:7168
    s_waitcnt vmcnt(11) lgkmcnt(10)
    v_mfma_f32_32x32x16_bf16 v[80:95], v[40:43], v[116:119], v[80:95]
    v_cmp_gt_u32 vcc, 4, v76
    s_cbranch_vccnz L_gs1
L_gb1:
    ds_read_b64_tr_b16 v[32:33], v12 offset:16384
    ds_read_b64_tr_b16 v[34:35], v12 offset:17408
    s_waitcnt lgkmcnt(10)
    v_mfma_f32_32x32x16_bf16 v[96:111], v[44:47], v[116:119], v[96:111]
    buffer_load_dwordx4 v[116:119], v18, s[16:19], s98 offen offset:1024 sc1
    ds_read_b64_tr_b16 v[36:37], v13 offset:16384
    ds_read_b64_tr_b16 v[38:39], v13 offset:17408
    s_waitcnt vmcnt(11) lgkmcnt(10)
    v_mfma_f32_32x32x16_bf16 v[80:95], v[48:51], v[120:123], v[80:95]
    ds_read_b64_tr_b16 v[40:41], v12 offset:18432
    ds_read_b64_tr_b16 v[42:43], v12 offset:19456
    s_waitcnt lgkmcnt(10)
    v_mfma_f32_32x32x16_bf16 v[96:111], v[52:55], v[120:123], v[96:111]
    buffer_load_dwordx4 v[120:123], v18, s[16:19], s98 offen offset:2048 sc1
    ds_read_b64_tr_b16 v[44:45], v13 offset:18432
    ds_read_b64_tr_b16 v[46:47], v13 offset:19456
    s_waitcnt vmcnt(11) lgkmcnt(10)
    v_mfma_f32_32x32x16_bf16 v[80:95], v[56:59], v[124:127], v[80:95]
    ds_read_b64_tr_b16 v[48:49], v12 offset:20480
    ds_read_b64_tr_b16 v[50:51], v12 offset:21504
    ds_read_b32 v76, v19 offset:32
    s_waitcnt lgkmcnt(11)
    v_mfma_f32_32x32x16_bf16 v[96:111], v[60:63], v[124:127], v[96:111]
    buffer_load_dwordx4 v[124:127], v18, s[16:19], s98 offen offset:3072 sc1
    ds_read_b64_tr_b16 v[52:53], v13 offset:20480
    ds_read_b64_tr_b16 v[54:55], v13 offset:21504
    s_waitcnt vmcnt(11) lgkmcnt(11)
    v_mfma_f32_32x32x16_bf16 v[80:95], v[32:35], v[128:131], v[80:95]
    ds_read_b64_tr_b16 v[56:57], v12 offset:22528
    ds_read_b64_tr_b16 v[58:59], v12 offset:23552
    s_waitcnt lgkmcnt(11)
    v_mfma_f32_32x32x16_bf16 v[96:111], v[36:39], v[128:131], v[96:111]
    buffer_load_dwordx4 v[128:131], v18, s[16:19], s99 offen offset:0 sc1
    ds_read_b64_tr_b16 v[60:61], v13 offset:22528
    ds_read_b64_tr_b16 v[62:63], v13 offset:23552
    s_waitcnt vmcnt(11) lgkmcnt(11)
    v_mfma_f32_32x32x16_bf16 v[80:95], v[40:43], v[132:135], v[80:95]
    s_waitcnt lgkmcnt(6)
    v_cmp_gt_u32 vcc, 5, v76
    s_cbranch_vccnz L_gs2
L_gb2:
    ds_read_b64_tr_b16 v[32:33], v12 offset:32768
    ds_read_b64_tr_b16 v[34:35], v12 offset:33792
    v_mfma_f32_32x32x16_bf16 v[96:111], v[44:47], v[132:135], v[96:111]
    buffer_load_dwordx4 v[132:135], v18, s[16:19], s99 offen offset:1024 sc1
    ds_read_b64_tr_b16 v[36:37], v13 offset:32768
    ds_read_b64_tr_b16 v[38:39], v13 offset:33792
    s_waitcnt vmcnt(11)
    v_mfma_f32_32x32x16_bf16 v[80:95], v[48:51], v[136:139], v[80:95]
    ds_read_b64_tr_b16 v[40:41], v12 offset:34816
    ds_read_b64_tr_b16 v[42:43], v12 offset:35840
    s_waitcnt lgkmcnt(10)
    v_mfma_f32_32x32x16_bf16 v[96:111], v[52:55], v[136:139], v[96:111]
    buffer_load_dwordx4 v[136:139], v18, s[16:19], s99 offen offset:2048 sc1
    ds_read_b64_tr_b16 v[44:45], v13 offset:34816
    ds_read_b64_tr_b16 v[46:47], v13 offset:35840
    s_waitcnt vmcnt(11) lgkmcnt(10)
    v_mfma_f32_32x32x16_bf16 v[80:95], v[56:59], v[140:143], v[80:95]
    ds_read_b64_tr_b16 v[48:49], v12 offset:36864
    ds_read_b64_tr_b16 v[50:51], v12 offset:37888
    ds_read_b32 v76, v19 offset:32
    s_waitcnt lgkmcnt(11)
    v_mfma_f32_32x32x16_bf16 v[96:111], v[60:63], v[140:143], v[96:111]
    buffer_load_dwordx4 v[140:143], v18, s[16:19], s99 offen offset:3072 sc1
    ds_read_b64_tr_b16 v[52:53], v13 offset:36864
    ds_read_b64_tr_b16 v[54:55], v13 offset:37888
    s_waitcnt vmcnt(11) lgkmcnt(11)
    v_mfma_f32_32x32x16_bf16 v[80:95], v[32:35], v[144:147], v[80:95]
    ds_read_b64_tr_b16 v[56:57], v12 offset:38912
    ds_read_b64_tr_b16 v[58:59], v12 offset:39936
    s_waitcnt lgkmcnt(11)
    v_mfma_f32_32x32x16_bf16 v[96:111], v[36:39], v[144:147], v[96:111]
    buffer_load_dwordx4 v[144:147], v18, s[16:19], s100 offen offset:0 sc1
    ds_read_b64_tr_b16 v[60:61], v13 offset:38912
    ds_read_b64_tr_b16 v[62:63], v13 offset:39936
    s_waitcnt vmcnt(11) lgkmcnt(11)
    v_mfma_f32_32x32x16_bf16 v[80:95], v[40:43], v[148:151], v[80:95]
    s_waitcnt lgkmcnt(6)
    v_cmp_gt_u32 vcc, 6, v76
    s_cbranch_vccnz L_gs3
L_gb3:
    ds_read_b64_tr_b16 v[32:33], v12 offset:49152
    ds_read_b64_tr_b16 v[34:35], v12 offset:50176
    v_mfma_f32_32x32x16_bf16 v[96:111], v[44:47], v[148:151], v[96:111]
    buffer_load_dwordx4 v[148:151], v18, s[16:19], s100 offen offset:1024 sc1
    ds_read_b64_tr_b16 v[36:37], v13 offset:49152
    ds_read_b64_tr_b16 v[38:39], v13 offset:50176
    s_waitcnt vmcnt(11)
    v_mfma_f32_32x32x16_bf16 v[80:95], v[48:51], v[152:155], v[80:95]
    ds_read_b64_tr_b16 v[40:41], v12 offset:51200
    ds_read_b64_tr_b16 v[42:43], v12 offset:52224
    s_waitcnt lgkmcnt(10)
    v_mfma_f32_32x32x16_bf16 v[96:111], v[52:55], v[152:155], v[96:111]
    buffer_load_dwordx4 v[152:155], v18, s[16:19], s100 offen offset:2048 sc1
    ds_read_b64_tr_b16 v[44:45], v13 offset:51200
    ds_read_b64_tr_b16 v[46:47], v13 offset:52224
    s_waitcnt vmcnt(11) lgkmcnt(10)
    v_mfma_f32_32x32x16_bf16 v[80:95], v[56:59], v[156:159], v[80:95]
    ds_read_b64_tr_b16 v[48:49], v12 offset:53248
    ds_read_b64_tr_b16 v[50:51], v12 offset:54272
    ds_read_b32 v76, v19 offset:32
    s_waitcnt lgkmcnt(11)
    v_mfma_f32_32x32x16_bf16 v[96:111], v[60:63], v[156:159], v[96:111]
    buffer_load_dwordx4 v[156:159], v18, s[16:19], s100 offen offset:3072 sc1
    ds_read_b64_tr_b16 v[52:53], v13 offset:53248
    ds_read_b64_tr_b16 v[54:55], v13 offset:54272
    s_waitcnt vmcnt(11) lgkmcnt(11)
    v_mfma_f32_32x32x16_bf16 v[80:95], v[32:35], v[112:115], v[80:95]
    ds_read_b64_tr_b16 v[56:57], v12 offset:55296
    ds_read_b64_tr_b16 v[58:59], v12 offset:56320
    s_waitcnt lgkmcnt(11)
    v_mfma_f32_32x32x16_bf16 v[96:111], v[36:39], v[112:115], v[96:111]
    buffer_load_dwordx4 v[112:115], v18, s[16:19], s101 offen offset:0 sc1
    ds_read_b64_tr_b16 v[60:61], v13 offset:55296
    ds_read_b64_tr_b16 v[62:63], v13 offset:56320
    s_waitcnt vmcnt(11) lgkmcnt(11)
    v_mfma_f32_32x32x16_bf16 v[80:95], v[40:43], v[116:119], v[80:95]
    s_waitcnt lgkmcnt(6)
    v_cmp_gt_u32 vcc, 7, v76
    s_cbranch_vccnz L_gs4
L_gb4:
    ds_read_b64_tr_b16 v[32:33], v10 offset:0
    ds_read_b64_tr_b16 v[34:35], v10 offset:1024
    v_mfma_f32_32x32x16_bf16 v[96:111], v[44:47], v[116:119], v[96:111]
    buffer_load_dwordx4 v[116:119], v18, s[16:19], s101 offen offset:1024 sc1
    ds_read_b64_tr_b16 v[36:37], v11 offset:0
    ds_read_b64_tr_b16 v[38:39], v11 offset:1024
    s_waitcnt vmcnt(11)
    v_mfma_f32_32x32x16_bf16 v[80:95], v[48:51], v[120:123], v[80:95]
    ds_read_b64_tr_b16 v[40:41], v10 offset:2048
    ds_read_b64_tr_b16 v[42:43], v10 offset:3072
    s_waitcnt lgkmcnt(10)
    v_mfma_f32_32x32x16_bf16 v[96:111], v[52:55], v[120:123], v[96:111]
    buffer_load_dwordx4 v[120:123], v18, s[16:19], s101 offen offset:2048 sc1
    ds_read_b64_tr_b16 v[44:45], v11 offset:2048
    ds_read_b64_tr_b16 v[46:47], v11 offset:3072
    s_waitcnt vmcnt(11) lgkmcnt(10)
    v_mfma_f32_32x32x16_bf16 v[80:95], v[56:59], v[124:127], v[80:95]
    ds_read_b64_tr_b16 v[48:49], v10 offset:4096
    ds_read_b64_tr_b16 v[50:51], v10 offset:5120
    ds_read_b32 v76, v19 offset:32
    s_waitcnt lgkmcnt(11)
    v_mfma_f32_32x32x16_bf16 v[96:111], v[60:63], v[124:127], v[96:111]
    buffer_load_dwordx4 v[124:127], v18, s[16:19], s101 offen offset:3072 sc1
    ds_read_b64_tr_b16 v[52:53], v11 offset:4096
    ds_read_b64_tr_b16 v[54:55], v11 offset:5120
    s_waitcnt vmcnt(11) lgkmcnt(11)
    v_mfma_f32_32x32x16_bf16 v[80:95], v[32:35], v[128:131], v[80:95]
    ds_read_b64_tr_b16 v[56:57], v10 offset:6144
    ds_read_b64_tr_b16 v[58:59], v10 offset:7168
    s_waitcnt lgkmcnt(11)
    v_mfma_f32_32x32x16_bf16 v[96:111], v[36:39], v[128:131], v[96:111]
    ds_read_b64_tr_b16 v[60:61], v11 offset:6144
    ds_read_b64_tr_b16 v[62:63], v11 offset:7168
    s_waitcnt vmcnt(10) lgkmcnt(11)
    v_mfma_f32_32x32x16_bf16 v[80:95], v[40:43], v[132:135], v[80:95]
    s_waitcnt lgkmcnt(6)
    v_cmp_gt_u32 vcc, 8, v76
    s_cbranch_vccnz L_gs5
L_gb5:
    ds_read_b64_tr_b16 v[32:33], v10 offset:16384
    ds_read_b64_tr_b16 v[34:35], v10 offset:17408
    v_mfma_f32_32x32x16_bf16 v[96:111], v[44:47], v[132:135], v[96:111]
    ds_read_b64_tr_b16 v[36:37], v11 offset:16384
    ds_read_b64_tr_b16 v[38:39], v11 offset:17408
    s_waitcnt vmcnt(9)
    v_mfma_f32_32x32x16_bf16 v[80:95], v[48:51], v[136:139], v[80:95]
    ds_read_b64_tr_b16 v[40:41], v10 offset:18432
    ds_read_b64_tr_b16 v[42:43], v10 offset:19456
    s_waitcnt lgkmcnt(10)
    v_mfma_f32_32x32x16_bf16 v[96:111], v[52:55], v[136:139], v[96:111]
    ds_read_b64_tr_b16 v[44:45], v11 offset:18432
    ds_read_b64_tr_b16 v[46:47], v11 offset:19456
    s_waitcnt vmcnt(8) lgkmcnt(10)
    v_mfma_f32_32x32x16_bf16 v[80:95], v[56:59], v[140:143], v[80:95]
    ds_read_b64_tr_b16 v[48:49], v10 offset:20480
    ds_read_b64_tr_b16 v[50:51], v10 offset:21504
    ds_read_b32 v76, v19 offset:32
    s_waitcnt lgkmcnt(11)
    v_mfma_f32_32x32x16_bf16 v[96:111], v[60:63], v[140:143], v[96:111]
    ds_read_b64_tr_b16 v[52:53], v11 offset:20480
    ds_read_b64_tr_b16 v[54:55], v11 offset:21504
    s_waitcnt vmcnt(7) lgkmcnt(11)
    v_mfma_f32_32x32x16_bf16 v[80:95], v[32:35], v[144:147], v[80:95]
    ds_read_b64_tr_b16 v[56:57], v10 offset:22528
    ds_read_b64_tr_b16 v[58:59], v10 offset:23552
    s_waitcnt lgkmcnt(11)
    v_mfma_f32_32x32x16_bf16 v[96:111], v[36:39], v[144:147], v[96:111]
    ds_read_b64_tr_b16 v[60:61], v11 offset:22528
    ds_read_b64_tr_b16 v[62:63], v11 offset:23552
    s_waitcnt vmcnt(6) lgkmcnt(11)
    v_mfma_f32_32x32x16_bf16 v[80:95], v[40:43], v[148:151], v[80:95]
    s_waitcnt lgkmcnt(6)
    v_cmp_gt_u32 vcc, 9, v76
    s_cbranch_vccnz L_gs6
L_gb6:
    ds_read_b64_tr_b16 v[32:33], v10 offset:32768
    ds_read_b64_tr_b16 v[34:35], v10 offset:33792
    v_mfma_f32_32x32x16_bf16 v[96:111], v[44:47], v[148:151], v[96:111]
    ds_read_b64_tr_b16 v[36:37], v11 offset:32768
    ds_read_b64_tr_b16 v[38:39], v11 offset:33792
    s_waitcnt vmcnt(5)
    v_mfma_f32_32x32x16_bf16 v[80:95], v[48:51], v[152:155], v[80:95]
    ds_read_b64_tr_b16 v[40:41], v10 offset:34816
    ds_read_b64_tr_b16 v[42:43], v10 offset:35840
    s_waitcnt lgkmcnt(10)
    v_mfma_f32_32x32x16_bf16 v[96:111], v[52:55], v[152:155], v[96:111]
    ds_read_b64_tr_b16 v[44:45], v11 offset:34816
    ds_read_b64_tr_b16 v[46:47], v11 offset:35840
    s_cmp_eq_u32 s60, 0
    s_cbranch_scc1 L_g2s
    buffer_load_dword v28, v16, s[32:35], 0 offen sc1
    buffer_load_dwordx4 v[64:67], v14, s[16:19], s95 offen offset:0 sc1
    buffer_load_dwordx4 v[68:71], v14, s[16:19], s95 offen offset:1024 sc1
    buffer_load_dwordx4 v[72:75], v14, s[16:19], s95 offen offset:2048 sc1
    s_mov_b64 exec, 1
    buffer_store_dwordx2 v[30:31], v5, s[16:19], s37 offen sc1
    s_mov_b64 exec, -1
    s_waitcnt vmcnt(9) lgkmcnt(10)
    v_mfma_f32_32x32x16_bf16 v[80:95], v[56:59], v[156:159], v[80:95]
    ds_read_b64_tr_b16 v[48:49], v10 offset:36864
    ds_read_b64_tr_b16 v[50:51], v10 offset:37888
    s_waitcnt lgkmcnt(10)
    v_mfma_f32_32x32x16_bf16 v[96:111], v[60:63], v[156:159], v[96:111]
    ds_read_b64_tr_b16 v[52:53], v11 offset:36864
    ds_read_b64_tr_b16 v[54:55], v11 offset:37888
    s_waitcnt vmcnt(8) lgkmcnt(10)
    v_mfma_f32_32x32x16_bf16 v[80:95], v[32:35], v[112:115], v[80:95]
    ds_read_b64_tr_b16 v[56:57], v10 offset:38912
    ds_read_b64_tr_b16 v[58:59], v10 offset:39936
    s_waitcnt lgkmcnt(10)
    v_mfma_f32_32x32x16_bf16 v[96:111], v[36:39], v[112:115], v[96:111]
    ds_read_b64_tr_b16 v[60:61], v11 offset:38912
    ds_read_b64_tr_b16 v[62:63], v11 offset:39936
    s_waitcnt vmcnt(7) lgkmcnt(10)
    v_mfma_f32_32x32x16_bf16 v[80:95], v[40:43], v[116:119], v[80:95]
    s_waitcnt lgkmcnt(8)
    v_mfma_f32_32x32x16_bf16 v[96:111], v[44:47], v[116:119], v[96:111]
    s_waitcnt vmcnt(6) lgkmcnt(6)
    v_mfma_f32_32x32x16_bf16 v[80:95], v[48:51], v[120:123], v[80:95]
    s_waitcnt lgkmcnt(4)
    v_mfma_f32_32x32x16_bf16 v[96:111], v[52:55], v[120:123], v[96:111]
    s_waitcnt vmcnt(5) lgkmcnt(2)
    s_waitcnt lgkmcnt(0)
    v_mfma_f32_32x32x16_bf16 v[96:111], v[60:63], v[124:127], v[96:111]
    v_mfma_f32_32x32x16_bf16 v[80:95], v[56:59], v[124:127], v[80:95]
    s_branch L_g2e
L_g2s:
    s_waitcnt vmcnt(4) lgkmcnt(10)
    v_mfma_f32_32x32x16_bf16 v[80:95], v[56:59], v[156:159], v[80:95]
    ds_read_b64_tr_b16 v[48:49], v10 offset:36864
    ds_read_b64_tr_b16 v[50:51], v10 offset:37888
    s_waitcnt lgkmcnt(10)
    v_mfma_f32_32x32x16_bf16 v[96:111], v[60:63], v[156:159], v[96:111]
    ds_read_b64_tr_b16 v[52:53], v11 offset:36864
    ds_read_b64_tr_b16 v[54:55], v11 offset:37888
    s_waitcnt vmcnt(3) lgkmcnt(10)
    v_mfma_f32_32x32x16_bf16 v[80:95], v[32:35], v[112:115], v[80:95]
    ds_read_b64_tr_b16 v[56:57], v10 offset:38912
    ds_read_b64_tr_b16 v[58:59], v10 offset:39936
    s_waitcnt lgkmcnt(10)
    v_mfma_f32_32x32x16_bf16 v[96:111], v[36:39], v[112:115], v[96:111]
    ds_read_b64_tr_b16 v[60:61], v11 offset:38912
    ds_read_b64_tr_b16 v[62:63], v11 offset:39936
    s_waitcnt vmcnt(2) lgkmcnt(10)
    v_mfma_f32_32x32x16_bf16 v[80:95], v[40:43], v[116:119], v[80:95]
    s_waitcnt lgkmcnt(8)
    v_mfma_f32_32x32x16_bf16 v[96:111], v[44:47], v[116:119], v[96:111]
    s_waitcnt vmcnt(1) lgkmcnt(6)
    v_mfma_f32_32x32x16_bf16 v[80:95], v[48:51], v[120:123], v[80:95]
    s_waitcnt lgkmcnt(4)
    v_mfma_f32_32x32x16_bf16 v[96:111], v[52:55], v[120:123], v[96:111]
    s_waitcnt vmcnt(0) lgkmcnt(2)
    s_waitcnt lgkmcnt(0)
    v_mfma_f32_32x32x16_bf16 v[96:111], v[60:63], v[124:127], v[96:111]
    v_mfma_f32_32x32x16_bf16 v[80:95], v[56:59], v[124:127], v[80:95]
L_g2e:
    s_cmp_eq_u32 s60, 0
    s_nop 7
    s_nop 1
    ds_write_b128 v162, v[96:99] offset:0
    ds_write_b128 v162, v[100:103] offset:1024
    ds_write_b128 v162, v[104:107] offset:2048
    ds_write_b128 v162, v[108:111] offset:3072
    s_mov_b64 exec, 1
    ds_write_b32 v165, v167 offset:64
    s_mov_b64 exec, -1
    s_cbranch_scc0 L_epiB
    s_xor_b32 s95, s95, 32768
    v_mov_b32 v67, s52
    v_mov_b32 v71, s52
    v_mov_b32 v75, s52
L_cwsa:
    ds_read_b32 v29, v164 offset:64
    s_add_u32 s59, s59, 1
    s_waitcnt lgkmcnt(0)
    v_cmp_gt_u32 vcc, 1, v29
    s_cmp_gt_u32 s59, 262144
    s_cbranch_scc1 L_cwsaok
    s_cbranch_vccz L_cwsaok
    s_sleep 0
    s_branch L_cwsa
L_cwsaok:
    ds_read_b128 v[32:35], v163 offset:0
    ds_read_b128 v[36:39], v163 offset:1024
    ds_read_b128 v[40:43], v163 offset:2048
    ds_read_b128 v[44:47], v163 offset:3072
    s_waitcnt lgkmcnt(3)
    v_add_f32 v32, v32, v80
    v_add_f32 v33, v33, v81
    v_cvt_pk_bf16_f32 v64, v32, v33
    v_add_f32 v34, v34, v82
    v_add_f32 v35, v35, v83
    v_cvt_pk_bf16_f32 v65, v34, v35
    s_waitcnt lgkmcnt(2)
    v_add_f32 v36, v36, v84
    v_add_f32 v37, v37, v85
    v_cvt_pk_bf16_f32 v66, v36, v37
    v_add_f32 v38, v38, v86
    v_add_f32 v39, v39, v87
    v_cvt_pk_bf16_f32 v68, v38, v39
    s_waitcnt lgkmcnt(1)
    v_add_f32 v40, v40, v88
    v_add_f32 v41, v41, v89
    v_cvt_pk_bf16_f32 v69, v40, v41
    v_add_f32 v42, v42, v90
    v_add_f32 v43, v43, v91
    v_cvt_pk_bf16_f32 v70, v42, v43
    s_waitcnt lgkmcnt(0)
    v_add_f32 v44, v44, v92
    v_add_f32 v45, v45, v93
    v_cvt_pk_bf16_f32 v72, v44, v45
    v_add_f32 v46, v46, v94
    v_add_f32 v47, v47, v95
    v_cvt_pk_bf16_f32 v73, v46, v47
    buffer_store_dwordx4 v[64:67], v14, s[16:19], s95 offen offset:0 sc1
    buffer_store_dwordx4 v[68:71], v14, s[16:19], s95 offen offset:1024 sc1
    buffer_store_dwordx4 v[72:75], v14, s[16:19], s95 offen offset:2048 sc1
    s_mov_b64 exec, 1
    buffer_store_dwordx2 v[30:31], v5, s[16:19], s37 offen sc1
    s_mov_b64 exec, -1
    s_endpgm
L_epiB:
L_xchk:
    s_waitcnt vmcnt(1)
    v_min3_u32 v48, v67, v71, v75
    v_max3_u32 v50, v67, v71, v75
    v_min_u32 v48, v48, v28
    v_max_u32 v50, v50, v28
    v_cmp_ne_u32 vcc, v48, v50
    v_cmp_eq_u32 s[54:55], 0, v28
    s_add_u32 s59, s59, 1
    s_cmp_gt_u32 s59, 262144
    s_cbranch_scc1 L_xok
    s_or_b64 vcc, vcc, s[54:55]
    s_cbranch_scc0 L_xok
    s_sleep 0
    buffer_load_dword v28, v16, s[32:35], 0 offen sc1
    buffer_load_dwordx4 v[64:67], v14, s[16:19], s95 offen offset:0 sc1
    buffer_load_dwordx4 v[68:71], v14, s[16:19], s95 offen offset:1024 sc1
    buffer_load_dwordx4 v[72:75], v14, s[16:19], s95 offen offset:2048 sc1
    s_waitcnt vmcnt(0)
    s_branch L_xchk
L_xok:
    v_lshlrev_b32 v48, 16, v64
    v_and_b32 v49, 0xffff0000, v64
    v_pk_add_f32 v[80:81], v[80:81], v[48:49]
    v_lshlrev_b32 v48, 16, v65
    v_and_b32 v49, 0xffff0000, v65
    v_pk_add_f32 v[82:83], v[82:83], v[48:49]
    v_lshlrev_b32 v48, 16, v66
    v_and_b32 v49, 0xffff0000, v66
    v_pk_add_f32 v[84:85], v[84:85], v[48:49]
    v_lshlrev_b32 v48, 16, v68
    v_and_b32 v49, 0xffff0000, v68
    v_pk_add_f32 v[86:87], v[86:87], v[48:49]
    v_lshlrev_b32 v48, 16, v69
    v_and_b32 v49, 0xffff0000, v69
    v_pk_add_f32 v[88:89], v[88:89], v[48:49]
    v_lshlrev_b32 v48, 16, v70
    v_and_b32 v49, 0xffff0000, v70
    v_pk_add_f32 v[90:91], v[90:91], v[48:49]
    v_lshlrev_b32 v48, 16, v72
    v_and_b32 v49, 0xffff0000, v72
    v_pk_add_f32 v[92:93], v[92:93], v[48:49]
    v_lshlrev_b32 v48, 16, v73
    v_and_b32 v49, 0xffff0000, v73
    v_pk_add_f32 v[94:95], v[94:95], v[48:49]
L_cwsb:
    ds_read_b32 v29, v164 offset:64
    s_add_u32 s59, s59, 1
    s_waitcnt lgkmcnt(0)
    v_cmp_gt_u32 vcc, 1, v29
    s_cmp_gt_u32 s59, 262144
    s_cbranch_scc1 L_cwsbok
    s_cbranch_vccz L_cwsbok
    s_sleep 0
    s_branch L_cwsb
L_cwsbok:
    ds_read_b128 v[32:35], v163 offset:0
    ds_read_b128 v[36:39], v163 offset:1024
    ds_read_b128 v[40:43], v163 offset:2048
    ds_read_b128 v[44:47], v163 offset:3072
    s_waitcnt lgkmcnt(3)
    v_pk_add_f32 v[32:33], v[32:33], v[80:81]
    v_cvt_pk_bf16_f32 v48, v32, v33
    v_pk_add_f32 v[34:35], v[34:35], v[82:83]
    v_cvt_pk_bf16_f32 v49, v34, v35
    s_waitcnt lgkmcnt(2)
    v_pk_add_f32 v[36:37], v[36:37], v[84:85]
    v_cvt_pk_bf16_f32 v50, v36, v37
    v_pk_add_f32 v[38:39], v[38:39], v[86:87]
    v_cvt_pk_bf16_f32 v51, v38, v39
    s_nop 1
    v_permlane32_swap_b32 v48, v50
    v_permlane32_swap_b32 v49, v51
    s_nop 0
    buffer_store_dwordx4 v[48:51], v6, s[20:23], 0 offen offset:0
    s_waitcnt lgkmcnt(1)
    v_pk_add_f32 v[40:41], v[40:41], v[88:89]
    v_cvt_pk_bf16_f32 v52, v40, v41
    v_pk_add_f32 v[42:43], v[42:43], v[90:91]
    v_cvt_pk_bf16_f32 v53, v42, v43
    s_waitcnt lgkmcnt(0)
    v_pk_add_f32 v[44:45], v[44:45], v[92:93]
    v_cvt_pk_bf16_f32 v54, v44, v45
    v_pk_add_f32 v[46:47], v[46:47], v[94:95]
    v_cvt_pk_bf16_f32 v55, v46, v47
    s_nop 1
    v_permlane32_swap_b32 v52, v54
    v_permlane32_swap_b32 v53, v55
    s_nop 0
    buffer_store_dwordx4 v[52:55], v6, s[20:23], 0 offen offset:32
L_end:
    s_endpgm
    .p2align 6
L_warm:
    s_branch L_warmb
L_ld_tail:
    s_lshl_b32 s50, s36, 1
    s_sub_u32 s50, s50, 1
    s_mul_i32 s50, s50, 57344
    v_add_u32 v20, s50, v20
    v_add_u32 v21, s50, v21
    s_lshl_b32 s50, s53, 7
    s_add_u32 m0, s57, 16384
    s_add_u32 s53, s53, 2
    s_cmp_ge_u32 s53, 7
    s_cselect_b32 s52, 7, 0
    s_sub_u32 s53, s53, s52
    buffer_load_dwordx4 v20, s[4:7], s50 offen lds
    buffer_load_dwordx4 v21, s[4:7], s50 offen offset:1024 lds
    s_lshl_b32 s50, s53, 7
    s_add_u32 m0, s57, 24576
    s_add_u32 s53, s53, 2
    s_cmp_ge_u32 s53, 7
    s_cselect_b32 s52, 7, 0
    s_sub_u32 s53, s53, s52
    buffer_load_dwordx4 v20, s[4:7], s50 offen lds
    buffer_load_dwordx4 v21, s[4:7], s50 offen offset:1024 lds
    s_waitcnt vmcnt(4)
    s_barrier
    s_lshl_b32 s50, s53, 7
    s_add_u32 m0, s57, 32768
    s_add_u32 s53, s53, 2
    s_cmp_ge_u32 s53, 7
    s_cselect_b32 s52, 7, 0
    s_sub_u32 s53, s53, s52
    buffer_load_dwordx4 v20, s[4:7], s50 offen lds
    buffer_load_dwordx4 v21, s[4:7], s50 offen offset:1024 lds
    s_lshl_b32 s50, s94, 5
    v_add_u32 v5, s50, v1
    v_mul_u32_u24 v5, 896, v5
    v_and_b32 v6, 1, v2
    v_lshlrev_b32 v6, 2, v6
    v_xor_b32 v6, v6, v3
    v_lshl_add_u32 v24, v6, 4, v5
    s_lshl_b32 s50, s45, 7
    s_mul_i32 s51, s36, 802816
    s_add_u32 s50, s50, s51
    v_add_u32 v24, s50, v24
    v_add_u32 v25, 6144, v24
    v_add_u32 v26, 12288, v24
    v_add_u32 v27, 18432, v24
    v_and_b32 v19, 3, v0
    v_lshlrev_b32 v19, 2, v19
    v_add_u32 v19, 40960, v19
    s_lshl_b32 s50, s3, 2
    s_add_u32 s50, s50, 40960
    v_mov_b32 v8, s50
    s_mov_b32 s56, s45
    s_waitcnt vmcnt(0)
    s_barrier
    s_lshl_b32 s50, s53, 7
    s_add_u32 m0, s57, 0
    s_add_u32 s53, s53, 2
    s_cmp_ge_u32 s53, 7
    s_cselect_b32 s52, 7, 0
    s_sub_u32 s53, s53, s52
    buffer_load_dwordx4 v20, s[4:7], s50 offen lds
    buffer_load_dwordx4 v21, s[4:7], s50 offen offset:1024 lds
    s_lshl_b32 s50, s53, 7
    s_add_u32 m0, s57, 8192
    s_add_u32 s53, s53, 2
    s_cmp_ge_u32 s53, 7
    s_cselect_b32 s52, 7, 0
    s_sub_u32 s53, s53, s52
    buffer_load_dwordx4 v20, s[4:7], s50 offen lds
    buffer_load_dwordx4 v21, s[4:7], s50 offen offset:1024 lds
    s_waitcnt vmcnt(0)
    v_mov_b32 v10, 1
    s_mov_b64 exec, 1
    ds_write_b32 v8, v10
    s_mov_b64 exec, -1
L_cww0:
    ds_read_b32 v12, v19 offset:16
    s_add_u32 s59, s59, 1
    s_waitcnt lgkmcnt(0)
    v_cmp_gt_u32 vcc, 1, v12
    s_cmp_gt_u32 s59, 262144
    s_cbranch_scc1 L_cww0ok
    s_cbranch_vccz L_cww0ok
    s_sleep 1
    s_branch L_cww0
L_cww0ok:
    s_lshl_b32 s50, s53, 7
    s_add_u32 m0, s57, 16384
    s_add_u32 s53, s53, 2
    s_cmp_ge_u32 s53, 7
    s_cselect_b32 s52, 7, 0
    s_sub_u32 s53, s53, s52
    buffer_load_dwordx4 v20, s[4:7], s50 offen lds
    buffer_load_dwordx4 v21, s[4:7], s50 offen offset:1024 lds
    s_add_u32 m0, s58, 0
    s_mul_i32 s50, s56, 114688
    s_add_u32 s56, s56, 1
    s_cmp_eq_u32 s56, 7
    s_cselect_b32 s56, 0, s56
    buffer_load_dwordx4 v24, s[12:15], s50 offen offset:0 lds
    buffer_load_dwordx4 v25, s[12:15], s50 offen offset:1024 lds
    buffer_load_dwordx4 v26, s[12:15], s50 offen offset:2048 lds
    buffer_load_dwordx4 v27, s[12:15], s50 offen offset:3072 lds
L_cww1:
    ds_read_b32 v12, v19 offset:16
    s_add_u32 s59, s59, 1
    s_waitcnt lgkmcnt(0)
    v_cmp_gt_u32 vcc, 2, v12
    s_cmp_gt_u32 s59, 262144
    s_cbranch_scc1 L_cww1ok
    s_cbranch_vccz L_cww1ok
    s_sleep 1
    s_branch L_cww1
L_cww1ok:
    s_lshl_b32 s50, s53, 7
    s_add_u32 m0, s57, 24576
    s_add_u32 s53, s53, 2
    s_cmp_ge_u32 s53, 7
    s_cselect_b32 s52, 7, 0
    s_sub_u32 s53, s53, s52
    buffer_load_dwordx4 v20, s[4:7], s50 offen lds
    buffer_load_dwordx4 v21, s[4:7], s50 offen offset:1024 lds
    s_add_u32 m0, s58, 16384
    s_mul_i32 s50, s56, 114688
    s_add_u32 s56, s56, 1
    s_cmp_eq_u32 s56, 7
    s_cselect_b32 s56, 0, s56
    buffer_load_dwordx4 v24, s[12:15], s50 offen offset:0 lds
    buffer_load_dwordx4 v25, s[12:15], s50 offen offset:1024 lds
    buffer_load_dwordx4 v26, s[12:15], s50 offen offset:2048 lds
    buffer_load_dwordx4 v27, s[12:15], s50 offen offset:3072 lds
    s_waitcnt vmcnt(4)
    v_mov_b32 v10, 3
    s_mov_b64 exec, 1
    ds_write_b32 v8, v10
    s_mov_b64 exec, -1
L_cww2:
    ds_read_b32 v12, v19 offset:16
    s_add_u32 s59, s59, 1
    s_waitcnt lgkmcnt(0)
    v_cmp_gt_u32 vcc, 3, v12
    s_cmp_gt_u32 s59, 262144
    s_cbranch_scc1 L_cww2ok
    s_cbranch_vccz L_cww2ok
    s_sleep 1
    s_branch L_cww2
L_cww2ok:
    s_add_u32 m0, s58, 32768
    s_mul_i32 s50, s56, 114688
    s_add_u32 s56, s56, 1
    s_cmp_eq_u32 s56, 7
    s_cselect_b32 s56, 0, s56
    buffer_load_dwordx4 v24, s[12:15], s50 offen offset:0 lds
    buffer_load_dwordx4 v25, s[12:15], s50 offen offset:1024 lds
    buffer_load_dwordx4 v26, s[12:15], s50 offen offset:2048 lds
    buffer_load_dwordx4 v27, s[12:15], s50 offen offset:3072 lds
L_cww3:
    ds_read_b32 v12, v19 offset:16
    s_add_u32 s59, s59, 1
    s_waitcnt lgkmcnt(0)
    v_cmp_gt_u32 vcc, 4, v12
    s_cmp_gt_u32 s59, 262144
    s_cbranch_scc1 L_cww3ok
    s_cbranch_vccz L_cww3ok
    s_sleep 1
    s_branch L_cww3
L_cww3ok:
    s_add_u32 m0, s58, 49152
    s_mul_i32 s50, s56, 114688
    s_add_u32 s56, s56, 1
    s_cmp_eq_u32 s56, 7
    s_cselect_b32 s56, 0, s56
    buffer_load_dwordx4 v24, s[12:15], s50 offen offset:0 lds
    buffer_load_dwordx4 v25, s[12:15], s50 offen offset:1024 lds
    buffer_load_dwordx4 v26, s[12:15], s50 offen offset:2048 lds
    buffer_load_dwordx4 v27, s[12:15], s50 offen offset:3072 lds
    s_waitcnt vmcnt(8)
    v_mov_b32 v10, 4
    s_mov_b64 exec, 1
    ds_write_b32 v8, v10
    s_mov_b64 exec, -1
L_cww4:
    ds_read_b32 v12, v19 offset:16
    s_add_u32 s59, s59, 1
    s_waitcnt lgkmcnt(0)
    v_cmp_gt_u32 vcc, 5, v12
    s_cmp_gt_u32 s59, 262144
    s_cbranch_scc1 L_cww4ok
    s_cbranch_vccz L_cww4ok
    s_sleep 1
    s_branch L_cww4
L_cww4ok:
    s_add_u32 m0, s58, 65536
    s_mul_i32 s50, s56, 114688
    s_add_u32 s56, s56, 1
    s_cmp_eq_u32 s56, 7
    s_cselect_b32 s56, 0, s56
    buffer_load_dwordx4 v24, s[12:15], s50 offen offset:0 lds
    buffer_load_dwordx4 v25, s[12:15], s50 offen offset:1024 lds
    buffer_load_dwordx4 v26, s[12:15], s50 offen offset:2048 lds
    buffer_load_dwordx4 v27, s[12:15], s50 offen offset:3072 lds
    s_waitcnt vmcnt(8)
    v_mov_b32 v10, 5
    s_mov_b64 exec, 1
    ds_write_b32 v8, v10
    s_mov_b64 exec, -1
L_cww5:
    ds_read_b32 v12, v19 offset:16
    s_add_u32 s59, s59, 1
    s_waitcnt lgkmcnt(0)
    v_cmp_gt_u32 vcc, 6, v12
    s_cmp_gt_u32 s59, 262144
    s_cbranch_scc1 L_cww5ok
    s_cbranch_vccz L_cww5ok
    s_sleep 1
    s_branch L_cww5
L_cww5ok:
    s_add_u32 m0, s58, 81920
    s_mul_i32 s50, s56, 114688
    s_add_u32 s56, s56, 1
    s_cmp_eq_u32 s56, 7
    s_cselect_b32 s56, 0, s56
    buffer_load_dwordx4 v24, s[12:15], s50 offen offset:0 lds
    buffer_load_dwordx4 v25, s[12:15], s50 offen offset:1024 lds
    buffer_load_dwordx4 v26, s[12:15], s50 offen offset:2048 lds
    buffer_load_dwordx4 v27, s[12:15], s50 offen offset:3072 lds
    s_waitcnt vmcnt(8)
    v_mov_b32 v10, 6
    s_mov_b64 exec, 1
    ds_write_b32 v8, v10
    s_mov_b64 exec, -1
L_cww6:
    ds_read_b32 v12, v19 offset:16
    s_add_u32 s59, s59, 1
    s_waitcnt lgkmcnt(0)
    v_cmp_gt_u32 vcc, 7, v12
    s_cmp_gt_u32 s59, 262144
    s_cbranch_scc1 L_cww6ok
    s_cbranch_vccz L_cww6ok
    s_sleep 1
    s_branch L_cww6
L_cww6ok:
    s_add_u32 m0, s58, 98304
    s_mul_i32 s50, s56, 114688
    s_add_u32 s56, s56, 1
    s_cmp_eq_u32 s56, 7
    s_cselect_b32 s56, 0, s56
    buffer_load_dwordx4 v24, s[12:15], s50 offen offset:0 lds
    buffer_load_dwordx4 v25, s[12:15], s50 offen offset:1024 lds
    buffer_load_dwordx4 v26, s[12:15], s50 offen offset:2048 lds
    buffer_load_dwordx4 v27, s[12:15], s50 offen offset:3072 lds
    s_waitcnt vmcnt(8)
    v_mov_b32 v10, 7
    s_mov_b64 exec, 1
    ds_write_b32 v8, v10
    s_mov_b64 exec, -1
    s_waitcnt vmcnt(4)
    v_mov_b32 v10, 8
    s_mov_b64 exec, 1
    ds_write_b32 v8, v10
    s_mov_b64 exec, -1
    s_waitcnt vmcnt(0)
    v_mov_b32 v10, 9
    s_mov_b64 exec, 1
    ds_write_b32 v8, v10
    s_mov_b64 exec, -1
    s_endpgm
L_gs1:
L_cwg1:
    ds_read_b32 v76, v19 offset:32
    s_add_u32 s59, s59, 1
    s_waitcnt lgkmcnt(0)
    v_cmp_gt_u32 vcc, 4, v76
    s_cmp_gt_u32 s59, 262144
    s_cbranch_scc1 L_cwg1ok
    s_cbranch_vccz L_cwg1ok
    s_sleep 1
    s_branch L_cwg1
L_cwg1ok:
    s_branch L_gb1
L_gs2:
L_cwg2:
    ds_read_b32 v76, v19 offset:32
    s_add_u32 s59, s59, 1
    s_waitcnt lgkmcnt(0)
    v_cmp_gt_u32 vcc, 5, v76
    s_cmp_gt_u32 s59, 262144
    s_cbranch_scc1 L_cwg2ok
    s_cbranch_vccz L_cwg2ok
    s_sleep 1
    s_branch L_cwg2
L_cwg2ok:
    s_branch L_gb2
L_gs3:
L_cwg3:
    ds_read_b32 v76, v19 offset:32
    s_add_u32 s59, s59, 1
    s_waitcnt lgkmcnt(0)
    v_cmp_gt_u32 vcc, 6, v76
    s_cmp_gt_u32 s59, 262144
    s_cbranch_scc1 L_cwg3ok
    s_cbranch_vccz L_cwg3ok
    s_sleep 1
    s_branch L_cwg3
L_cwg3ok:
    s_branch L_gb3
L_gs4:
L_cwg4:
    ds_read_b32 v76, v19 offset:32
    s_add_u32 s59, s59, 1
    s_waitcnt lgkmcnt(0)
    v_cmp_gt_u32 vcc, 7, v76
    s_cmp_gt_u32 s59, 262144
    s_cbranch_scc1 L_cwg4ok
    s_cbranch_vccz L_cwg4ok
    s_sleep 1
    s_branch L_cwg4
L_cwg4ok:
    s_branch L_gb4
L_gs5:
L_cwg5:
    ds_read_b32 v76, v19 offset:32
    s_add_u32 s59, s59, 1
    s_waitcnt lgkmcnt(0)
    v_cmp_gt_u32 vcc, 8, v76
    s_cmp_gt_u32 s59, 262144
    s_cbranch_scc1 L_cwg5ok
    s_cbranch_vccz L_cwg5ok
    s_sleep 1
    s_branch L_cwg5
L_cwg5ok:
    s_branch L_gb5
L_gs6:
L_cwg6:
    ds_read_b32 v76, v19 offset:32
    s_add_u32 s59, s59, 1
    s_waitcnt lgkmcnt(0)
    v_cmp_gt_u32 vcc, 9, v76
    s_cmp_gt_u32 s59, 262144
    s_cbranch_scc1 L_cwg6ok
    s_cbranch_vccz L_cwg6ok
    s_sleep 1
    s_branch L_cwg6
L_cwg6ok:
    s_branch L_gb6
L_ks3:
L_cwk3:
    ds_read_b32 v144, v19 offset:32
    s_add_u32 s59, s59, 1
    s_waitcnt lgkmcnt(0)
    v_cmp_gt_u32 vcc, 1, v144
    s_cmp_gt_u32 s59, 262144
    s_cbranch_scc1 L_cwk3ok
    s_cbranch_vccz L_cwk3ok
    s_sleep 0
    s_branch L_cwk3
L_cwk3ok:
    s_branch L_kb3
L_ks5:
L_cwk5:
    ds_read_b32 v144, v19 offset:32
    s_add_u32 s59, s59, 1
    s_waitcnt lgkmcnt(0)
    v_cmp_gt_u32 vcc, 2, v144
    s_cmp_gt_u32 s59, 262144
    s_cbranch_scc1 L_cwk5ok
    s_cbranch_vccz L_cwk5ok
    s_sleep 0
    s_branch L_cwk5
L_cwk5ok:
    s_branch L_kb5
L_helper:
    s_cmp_ge_u32 s2, 256
    s_cbranch_scc1 L_end
    s_load_dwordx2 s[12:13], s[0:1], 24
    s_load_dwordx2 s[16:17], s[0:1], 56
    s_load_dwordx2 s[4:5], s[0:1], 0
    s_and_b32 s36, s2, 1
    s_sub_u32 s50, s2, 224
    s_lshr_b32 s50, s50, 3
    s_bfe_u32 s53, s2, 0x20001
    s_lshl_b32 s53, s53, 2
    s_add_u32 s53, s53, s50
    s_lshl_b32 s53, s53, 1
    s_add_u32 s53, s53, s36
    s_mul_i32 s53, s53, 57344
    s_add_u32 s6, s53, 57344
    s_mov_b32 s7, 0x20000
    s_and_b32 s52, s2, 7
    s_lshl_b32 s52, s52, 2
    s_add_u32 s52, s52, s50
    s_lshl_b32 s52, s52, 9
    s_add_u32 s52, s52, 8388608
    s_add_u32 s18, s52, 512
    s_mov_b32 s19, 0x20000
    s_mul_i32 s51, s36, 802816
    s_mul_i32 s50, s50, 200704
    s_add_u32 s50, s50, s51
    s_add_u32 s14, s50, 200704
    s_mov_b32 s15, 0x20000
    v_lshlrev_b32 v1, 7, v0
    s_waitcnt lgkmcnt(0)
    buffer_load_dword v6, v1, s[16:19], s52 offen sc1
    s_sub_u32 s54, s2, 224
    s_lshr_b32 s54, s54, 3
    s_lshl_b32 s54, s54, 5
    s_mul_i32 s55, s36, 896
    s_add_u32 s54, s54, s55
    s_mov_b32 s14, 1605632
    v_and_b32 v11, 31, v0
    v_add_u32 v11, s54, v11
    v_add_u32 v8, 0, v0
    v_lshrrev_b32 v8, 5, v8
    v_mul_u32_u24 v9, 37, v8
    v_lshrrev_b32 v9, 8, v9
    v_mul_u32_u24 v10, 7, v9
    v_sub_u32 v10, v8, v10
    v_add_u32 v9, v9, v10
    v_subrev_u32 v12, 7, v9
    v_min_u32 v9, v9, v12
    v_lshl_add_u32 v9, v9, 7, v11
    v_mul_u32_u24 v9, 896, v9
    v_lshl_add_u32 v9, v10, 7, v9
    v_cmp_gt_u32 vcc, 49, v8
    v_mov_b32 v10, 0x7fffff00
    s_nop 0
    v_cndmask_b32 v9, v10, v9, vcc
    buffer_load_dword v2, v9, s[12:15], 0 offen
    v_add_u32 v8, 768, v0
    v_lshrrev_b32 v8, 5, v8
    v_mul_u32_u24 v9, 37, v8
    v_lshrrev_b32 v9, 8, v9
    v_mul_u32_u24 v10, 7, v9
    v_sub_u32 v10, v8, v10
    v_add_u32 v9, v9, v10
    v_subrev_u32 v12, 7, v9
    v_min_u32 v9, v9, v12
    v_lshl_add_u32 v9, v9, 7, v11
    v_mul_u32_u24 v9, 896, v9
    v_lshl_add_u32 v9, v10, 7, v9
    v_cmp_gt_u32 vcc, 49, v8
    v_mov_b32 v10, 0x7fffff00
    s_nop 0
    v_cndmask_b32 v9, v10, v9, vcc
    buffer_load_dword v3, v9, s[12:15], 0 offen
    v_add_u32 v8, 1536, v0
    v_lshrrev_b32 v8, 5, v8
    v_mul_u32_u24 v9, 37, v8
    v_lshrrev_b32 v9, 8, v9
    v_mul_u32_u24 v10, 7, v9
    v_sub_u32 v10, v8, v10
    v_add_u32 v9, v9, v10
    v_subrev_u32 v12, 7, v9
    v_min_u32 v9, v9, v12
    v_lshl_add_u32 v9, v9, 7, v11
    v_mul_u32_u24 v9, 896, v9
    v_lshl_add_u32 v9, v10, 7, v9
    v_cmp_gt_u32 vcc, 49, v8
    v_mov_b32 v10, 0x7fffff00
    s_nop 0
    v_cndmask_b32 v9, v10, v9, vcc
    buffer_load_dword v4, v9, s[12:15], 0 offen
    s_waitcnt vmcnt(0)
    s_endpgm
L_code_end:
.section .rodata,"a"
.p2align 6
.amdhsa_kernel standalone__dense_activation_gelu__prompt_kernel
  .amdhsa_next_free_vgpr 168
  .amdhsa_next_free_sgpr 102
  .amdhsa_accum_offset 168
  .amdhsa_group_segment_fixed_size 0
  .amdhsa_kernarg_size 64
  .amdhsa_user_sgpr_count 2
  .amdhsa_user_sgpr_kernarg_segment_ptr 1
  .amdhsa_system_sgpr_workgroup_id_x 1
.end_amdhsa_kernel
```
